```python
import torch

def _softmax(x, axis=-1):
    return torch.softmax(x, dim=axis)
def _gelu(x):
    return torch.nn.functional.gelu(x, approximate="tanh")
def _silu(x):
    return torch.nn.functional.silu(x)
def _sigmoid(x):
    return torch.sigmoid(x)
def _layernorm(x, axis=-1, eps=1e-5):
    m = x.mean(dim=axis, keepdim=True)
    v = x.var(dim=axis, keepdim=True, unbiased=False)
    return (x - m) / torch.sqrt(v + eps)
def _scatter_add(tgt, idx, src, axis=0):
    return tgt.clone().index_add_(axis, idx, src)
def _segment_sum(src, seg, n):
    out = torch.zeros((n,) + src.shape[1:], dtype=src.dtype)
    return out.index_add_(0, seg, src)
def _pad(x, pw):
    flat = tuple(v for pair in reversed(pw) for v in pair)
    return torch.nn.functional.pad(x, flat)

kernel_name = 'sequential_preLN__ssm_conv_h3__dense_activation_gelu__prompt'

def setup_inputs():

    _w = (lambda a: (lambda t: t.to(torch.bfloat16) if t.is_floating_point() else t)(torch.as_tensor(a)))
    def _A_setup():
        B, S, D = 1, 2048, 640
        ks = 4
        return {
            "q": _w((lambda *s: torch.randn(*s, dtype=torch.bfloat16) * 0.05)(B, S, D)),
            "k": _w((lambda *s: torch.randn(*s, dtype=torch.bfloat16) * 0.2)(B, S, D)),
            "v": _w((lambda *s: torch.randn(*s, dtype=torch.bfloat16) * 0.2)(B, S, D)),
            "shift_k": _w((lambda *s: torch.randn(*s, dtype=torch.bfloat16) * 0.2)(D, ks) * 0.5),
            "ssm_k": _w((lambda *s: torch.randn(*s, dtype=torch.bfloat16) * 0.8)(D, S) * (1.0 / S ** 0.5)),
            "ssm_D": _w((lambda *s: torch.randn(*s, dtype=torch.bfloat16) * 0.2)(D)),
        }
    _A_in = _A_setup()

    def _B_setup():
        B, S, D, F = 1, 2048, 640, 1536
        return {
            "x": _w((lambda *s: torch.randn(*s, dtype=torch.bfloat16) * 0.05)(B, S, D)),
            "w1": _w((lambda *s: torch.randn(*s, dtype=torch.bfloat16) * 0.4)(D, F) * (D ** -0.5)),
            "b1": _w((lambda *s: torch.randn(*s, dtype=torch.bfloat16) * 12.8)(F) * 0.01),
            "w2": _w((lambda *s: torch.randn(*s, dtype=torch.bfloat16) * 0.2)(F, D) * (F ** -0.5)),
            "b2": _w((lambda *s: torch.randn(*s, dtype=torch.bfloat16) * 3.2)(D) * 0.01),
        }
    _B_in = _B_setup()

    return {
        "A_q": _A_in["q"],
        "A_k": _A_in["k"],
        "A_v": _A_in["v"],
        "A_shift_k": _A_in["shift_k"],
        "A_ssm_k": _A_in["ssm_k"],
        "A_ssm_D": _A_in["ssm_D"],
        "B_x": _B_in["x"],
        "B_w1": _B_in["w1"],
        "B_b1": _B_in["b1"],
        "B_w2": _B_in["w2"],
        "B_b2": _B_in["b2"],
    }

def reference(A_q, A_k, A_v, A_shift_k, A_ssm_k, A_ssm_D, B_x, B_w1, B_b1, B_w2, B_b2):
    def _A_ref(q, k, v, shift_k, ssm_k, ssm_D):
        B, S, D = q.shape
        ks = shift_k.shape[-1]
        k_pad = _pad(k, ((0, 0), (ks - 1, 0), (0, 0)))
        k_shift = torch.zeros_like(k)
        for t in range(ks):
            k_shift = k_shift + k_pad[:, t:t + S, :] * shift_k[:, ks - 1 - t][None, None, :]
        kv = k_shift * v
        L = 2 * S
        kv_pad = _pad(kv, ((0, 0), (0, S), (0, 0)))
        kf_pad = _pad(ssm_k, ((0, 0), (0, S)))
        kv_f = (lambda x, axes=(-2,-1): torch.fft.rfft2(x.float(), dim=axes))(kv_pad[:, None, :, :], axes=(1, 2))
        kf_f = (lambda x, axes=(-2,-1): torch.fft.rfft2(x.float(), dim=axes))(kf_pad[:, None, :], axes=(1, 2))
        kf_f = (lambda x, *d: x.permute(*d))(kf_f, 1, 2, 0)
        y_f = kv_f * kf_f[None, :, :, :]
        y = (lambda x, s, axes=(-2,-1): torch.fft.irfft2(x, s=s, dim=axes).to(torch.bfloat16))(y_f, (1, L), axes=(1, 2))[:, 0, :S, :]
        y = y + kv * ssm_D[None, None, :]
        return q * y

    def _B_ref(x, w1, b1, w2, b2):
        h = torch.einsum("bsd,df->bsf", x, w1) + b1
        h = _gelu(h)
        return torch.einsum("bsf,fd->bsd", h, w2) + b2

    x = A_q
    h = x + _A_ref(_layernorm(x, axis=-1), A_k, A_v, A_shift_k, A_ssm_k, A_ssm_D)
    h2 = h + _B_ref(_layernorm(h, axis=-1), B_w1, B_b1, B_w2, B_b2)
    return h2
```

```asm
; @launch grid=(256,1,1) block=(256,1,1) lds=160768
.amdgcn_target "amdgcn-amd-amdhsa--gfx950"
.text
.globl sequential_preLN__ssm_conv_h3__dense_activation_gelu__prompt_kernel
.p2align 8
.type sequential_preLN__ssm_conv_h3__dense_activation_gelu__prompt_kernel,@function
sequential_preLN__ssm_conv_h3__dense_activation_gelu__prompt_kernel:
    s_cmp_ge_u32 s2, 256
    s_cbranch_scc1 L_end
    s_load_dwordx16 s[32:47], s[0:1], 0
    s_load_dwordx8 s[48:55], s[0:1], 64
    s_load_dwordx4 s[56:59], s[0:1], 96
    v_lshrrev_b32 v1, 6, v0
    s_and_b32 s6, s2, 7
    v_readfirstlane_b32 s3, v1
    s_lshr_b32 s7, s2, 3
    s_lshr_b32 s4, s6, 1
    s_lshl_b32 s4, s4, 3
    s_and_b32 s60, s7, 7
    s_add_u32 s4, s4, s60
    s_and_b32 s5, s6, 1
    s_lshl_b32 s5, s5, 2
    s_lshr_b32 s60, s7, 3
    s_add_u32 s5, s5, s60
    v_and_b32 v0, 63, v0
    v_lshlrev_b32 v1, 4, v0
    v_lshrrev_b32 v2, 4, v0
    v_and_b32 v3, 15, v0
    s_getpc_b64 s[62:63]
L_pc:
    s_lshl_b32 s64, s7, 2
    s_add_u32 s64, s64, s3
    s_cmp_ge_u32 s64, 30
    s_cbranch_scc1 L_nopf
    s_lshl_b32 s64, s64, 10
    v_add_u32 v4, s64, v1
    global_load_dwordx4 a[252:255], v4, s[62:63]
L_nopf:
    s_cmp_ge_u32 s2, 160
    s_cbranch_scc1 L_helper
    s_and_b32 s60, s2, 15
    s_lshr_b32 s61, s2, 4
    v_and_b32 v4, 31, v0
    v_lshrrev_b32 v5, 5, v0
    s_lshl_b32 s62, s3, 1
    v_add_u32 v5, s62, v5
    s_mul_i32 s62, s60, 81920
    s_lshl_b32 s63, s61, 7
    s_add_u32 s62, s62, s63
    v_mul_u32_u24 v6, 10240, v5
    v_lshl_add_u32 v6, v4, 2, v6
    v_add_u32 v6, s62, v6
    v_subrev_u32 v7, 3840, v6
    v_subrev_u32 v8, 2560, v6
    v_subrev_u32 v9, 1280, v6
    v_add_u32 v42, 5120, v6
    s_lshl_b32 s63, s61, 9
    v_lshlrev_b32 v43, 4, v4
    v_add_u32 v43, s63, v43
    s_waitcnt lgkmcnt(0)
    s_or_b32 s74, s2, s3
    s_cmp_lg_u32 s74, 0
    s_cbranch_scc1 L_f_nonce_1
    s_mov_b32 s28, s56
    s_and_b32 s29, s57, 0xffff
    s_mov_b32 s30, 0x100
    s_mov_b32 s31, 0x00020000
    s_memrealtime s[74:75]
    s_waitcnt lgkmcnt(0)
    s_or_b32 s76, s74, 1
    s_mov_b64 exec, 1
    v_mov_b32 v252, s76
    v_mov_b32 v253, 0
    buffer_store_dword v252, v253, s[28:31], 0 offen sc0 sc1
    s_mov_b64 exec, -1
L_f_nonce_1:
    s_mov_b32 s20, s34
    s_and_b32 s21, s35, 0xffff
    s_mov_b32 s22, 0x280000
    s_mov_b32 s23, 0x00020000
    s_mov_b32 s24, s36
    s_and_b32 s25, s37, 0xffff
    s_mov_b32 s26, 0x280000
    s_mov_b32 s27, 0x00020000
    s_mov_b32 s64, s38
    s_and_b32 s65, s39, 0xffff
    s_mov_b32 s66, 0x1400
    s_mov_b32 s67, 0x00020000
    buffer_load_dwordx4 v[38:41], v43, s[64:67], 0 offen
    s_mov_b32 s68, 1310720
    s_mov_b32 s73, 1306880
    buffer_load_dword v10, v7, s[20:23], 0 offen nt
    buffer_load_dword v11, v8, s[20:23], 0 offen nt
    buffer_load_dword v12, v9, s[20:23], 0 offen nt
    buffer_load_dword v13, v6, s[20:23], 0 offen offset:0 nt
    buffer_load_dword v14, v6, s[20:23], 0 offen offset:1280 nt
    buffer_load_dword v15, v6, s[20:23], 0 offen offset:2560 nt
    buffer_load_dword v16, v6, s[20:23], 0 offen offset:3840 nt
    buffer_load_dword v17, v42, s[20:23], 0 offen offset:0 nt
    buffer_load_dword v18, v42, s[20:23], 0 offen offset:1280 nt
    buffer_load_dword v19, v42, s[20:23], 0 offen offset:2560 nt
    buffer_load_dword v20, v42, s[20:23], 0 offen offset:3840 nt
    buffer_load_dword v21, v6, s[24:27], 0 offen offset:0 nt
    buffer_load_dword v22, v6, s[24:27], 0 offen offset:1280 nt
    buffer_load_dword v23, v6, s[24:27], 0 offen offset:2560 nt
    buffer_load_dword v24, v6, s[24:27], 0 offen offset:3840 nt
    buffer_load_dword v25, v42, s[24:27], 0 offen offset:0 nt
    buffer_load_dword v26, v42, s[24:27], 0 offen offset:1280 nt
    buffer_load_dword v27, v42, s[24:27], 0 offen offset:2560 nt
    buffer_load_dword v28, v42, s[24:27], 0 offen offset:3840 nt
    buffer_load_dword v120, v6, s[20:23], s73 offen offset:0 nt
    buffer_load_dword v121, v6, s[20:23], s73 offen offset:1280 nt
    buffer_load_dword v122, v6, s[20:23], s73 offen offset:2560 nt
    buffer_load_dword v123, v6, s[20:23], s68 offen offset:0 nt
    buffer_load_dword v124, v6, s[20:23], s68 offen offset:1280 nt
    buffer_load_dword v125, v6, s[20:23], s68 offen offset:2560 nt
    buffer_load_dword v126, v6, s[20:23], s68 offen offset:3840 nt
    buffer_load_dword v127, v42, s[20:23], s68 offen offset:0 nt
    buffer_load_dword v128, v42, s[20:23], s68 offen offset:1280 nt
    buffer_load_dword v129, v42, s[20:23], s68 offen offset:2560 nt
    buffer_load_dword v130, v42, s[20:23], s68 offen offset:3840 nt
    buffer_load_dword v131, v6, s[24:27], s68 offen offset:0 nt
    buffer_load_dword v132, v6, s[24:27], s68 offen offset:1280 nt
    buffer_load_dword v133, v6, s[24:27], s68 offen offset:2560 nt
    buffer_load_dword v134, v6, s[24:27], s68 offen offset:3840 nt
    buffer_load_dword v135, v42, s[24:27], s68 offen offset:0 nt
    buffer_load_dword v136, v42, s[24:27], s68 offen offset:1280 nt
    buffer_load_dword v137, v42, s[24:27], s68 offen offset:2560 nt
    buffer_load_dword v138, v42, s[24:27], s68 offen offset:3840 nt
    s_add_u32 s58, s58, 0
    s_addc_u32 s59, s59, 0
    s_mov_b32 s8, s58
    s_and_b32 s9, s59, 0xffff
    s_mov_b32 s10, 0x2000000
    s_mov_b32 s11, 0x00020000
    s_mov_b32 s28, s56
    s_and_b32 s29, s57, 0xffff
    s_mov_b32 s30, 0x100
    s_mov_b32 s31, 0x00020000
    s_lshl_b32 s80, s2, 2
    s_add_u32 s80, s80, s3
    s_lshl_b32 s81, s80, 12
    s_add_u32 s64, s40, s81
    s_addc_u32 s65, s41, 0
    s_and_b32 s65, s65, 0xffff
    s_mov_b32 s66, 4096
    s_mov_b32 s67, 0x00020000
    buffer_load_dwordx4 v[160:163], v1, s[64:67], 0 offen offset:0 nt
    buffer_load_dwordx2 v[164:165], v1, s[64:67], 0 offen offset:16 nt
    buffer_load_dwordx4 v[166:169], v1, s[64:67], 0 offen offset:1024 nt
    buffer_load_dwordx2 v[170:171], v1, s[64:67], 0 offen offset:1040 nt
    buffer_load_dwordx4 v[172:175], v1, s[64:67], 0 offen offset:2048 nt
    buffer_load_dwordx2 v[176:177], v1, s[64:67], 0 offen offset:2064 nt
    buffer_load_dwordx4 v[178:181], v1, s[64:67], 0 offen offset:3072 nt
    buffer_load_dwordx2 v[182:183], v1, s[64:67], 0 offen offset:3088 nt
    v_add_u32 v209, v2, v3
    v_subrev_u32 v209, 15, v209
    v_lshlrev_b32 v209, 1, v209
    buffer_load_ushort v208, v209, s[64:67], 0 offen
    v_and_b32 v44, 7, v4
    v_sub_u32 v45, 7, v5
    v_xor_b32 v45, v45, v44
    v_lshlrev_b32 v45, 4, v45
    v_lshl_add_u32 v148, v4, 8, v45
    v_add_u32 v148, 101376, v148
    s_lshl_b32 s63, s3, 3
    v_lshrrev_b32 v45, 3, v0
    v_add_u32 v45, s63, v45
    v_and_b32 v46, 7, v0
    v_bfe_u32 v47, v45, 1, 3
    v_xor_b32 v47, v47, v46
    v_lshlrev_b32 v47, 4, v47
    v_lshl_add_u32 v150, v45, 7, v47
    v_add_u32 v150, 101376, v150
    v_lshlrev_b32 v47, 4, v46
    v_lshl_add_u32 v151, v45, 12, v47
    s_mov_b32 s70, 0xffff0000
    s_lshl_b32 s74, s61, 18
    s_lshl_b32 s75, s60, 7
    s_add_u32 s74, s74, 3968
    s_sub_u32 s74, s74, s75
    s_add_u32 s75, s74, 131072
    s_sub_u32 s76, s74, 2048
    s_add_u32 s77, s76, 131072
    s_waitcnt vmcnt(47)
    v_lshlrev_b32 v68, 16, v38
    v_lshlrev_b32 v69, 16, v40
    v_and_b32 v70, s70, v38
    v_and_b32 v71, s70, v40
    v_lshlrev_b32 v72, 16, v39
    v_lshlrev_b32 v73, 16, v41
    v_and_b32 v74, s70, v39
    v_and_b32 v75, s70, v41
    s_waitcnt vmcnt(36)
    v_lshlrev_b32 v44, 16, v10
    v_and_b32 v45, s70, v10
    v_lshlrev_b32 v46, 16, v11
    v_and_b32 v47, s70, v11
    v_lshlrev_b32 v48, 16, v12
    v_and_b32 v49, s70, v12
    v_lshlrev_b32 v50, 16, v13
    v_and_b32 v51, s70, v13
    v_lshlrev_b32 v52, 16, v14
    v_and_b32 v53, s70, v14
    v_lshlrev_b32 v54, 16, v15
    v_and_b32 v55, s70, v15
    v_lshlrev_b32 v56, 16, v16
    v_and_b32 v57, s70, v16
    v_lshlrev_b32 v58, 16, v17
    v_and_b32 v59, s70, v17
    v_lshlrev_b32 v60, 16, v18
    v_and_b32 v61, s70, v18
    v_lshlrev_b32 v62, 16, v19
    v_and_b32 v63, s70, v19
    v_lshlrev_b32 v64, 16, v20
    v_and_b32 v65, s70, v20
    v_pk_mul_f32 v[80:81], v[50:51], v[68:69]
    v_pk_mul_f32 v[82:83], v[52:53], v[68:69]
    v_pk_mul_f32 v[84:85], v[54:55], v[68:69]
    v_pk_mul_f32 v[86:87], v[56:57], v[68:69]
    v_pk_mul_f32 v[88:89], v[58:59], v[68:69]
    v_pk_mul_f32 v[90:91], v[60:61], v[68:69]
    v_pk_mul_f32 v[92:93], v[62:63], v[68:69]
    v_pk_mul_f32 v[94:95], v[64:65], v[68:69]
    v_pk_fma_f32 v[80:81], v[48:49], v[70:71], v[80:81]
    v_pk_fma_f32 v[82:83], v[50:51], v[70:71], v[82:83]
    v_pk_fma_f32 v[84:85], v[52:53], v[70:71], v[84:85]
    v_pk_fma_f32 v[86:87], v[54:55], v[70:71], v[86:87]
    v_pk_fma_f32 v[88:89], v[56:57], v[70:71], v[88:89]
    v_pk_fma_f32 v[90:91], v[58:59], v[70:71], v[90:91]
    v_pk_fma_f32 v[92:93], v[60:61], v[70:71], v[92:93]
    v_pk_fma_f32 v[94:95], v[62:63], v[70:71], v[94:95]
    v_pk_fma_f32 v[80:81], v[46:47], v[72:73], v[80:81]
    v_pk_fma_f32 v[82:83], v[48:49], v[72:73], v[82:83]
    v_pk_fma_f32 v[84:85], v[50:51], v[72:73], v[84:85]
    v_pk_fma_f32 v[86:87], v[52:53], v[72:73], v[86:87]
    v_pk_fma_f32 v[88:89], v[54:55], v[72:73], v[88:89]
    v_pk_fma_f32 v[90:91], v[56:57], v[72:73], v[90:91]
    v_pk_fma_f32 v[92:93], v[58:59], v[72:73], v[92:93]
    v_pk_fma_f32 v[94:95], v[60:61], v[72:73], v[94:95]
    v_pk_fma_f32 v[80:81], v[44:45], v[74:75], v[80:81]
    v_pk_fma_f32 v[82:83], v[46:47], v[74:75], v[82:83]
    v_pk_fma_f32 v[84:85], v[48:49], v[74:75], v[84:85]
    v_pk_fma_f32 v[86:87], v[50:51], v[74:75], v[86:87]
    v_pk_fma_f32 v[88:89], v[52:53], v[74:75], v[88:89]
    v_pk_fma_f32 v[90:91], v[54:55], v[74:75], v[90:91]
    v_pk_fma_f32 v[92:93], v[56:57], v[74:75], v[92:93]
    v_pk_fma_f32 v[94:95], v[58:59], v[74:75], v[94:95]
    s_waitcnt vmcnt(28)
    v_lshlrev_b32 v96, 16, v21
    v_and_b32 v97, s70, v21
    v_pk_mul_f32 v[80:81], v[80:81], v[96:97]
    v_lshlrev_b32 v98, 16, v22
    v_and_b32 v99, s70, v22
    v_pk_mul_f32 v[82:83], v[82:83], v[98:99]
    v_lshlrev_b32 v96, 16, v23
    v_and_b32 v97, s70, v23
    v_pk_mul_f32 v[84:85], v[84:85], v[96:97]
    v_lshlrev_b32 v98, 16, v24
    v_and_b32 v99, s70, v24
    v_pk_mul_f32 v[86:87], v[86:87], v[98:99]
    v_lshlrev_b32 v96, 16, v25
    v_and_b32 v97, s70, v25
    v_pk_mul_f32 v[88:89], v[88:89], v[96:97]
    v_lshlrev_b32 v98, 16, v26
    v_and_b32 v99, s70, v26
    v_pk_mul_f32 v[90:91], v[90:91], v[98:99]
    v_lshlrev_b32 v96, 16, v27
    v_and_b32 v97, s70, v27
    v_pk_mul_f32 v[92:93], v[92:93], v[96:97]
    v_lshlrev_b32 v98, 16, v28
    v_and_b32 v99, s70, v28
    v_pk_mul_f32 v[94:95], v[94:95], v[98:99]
    v_cvt_pk_bf16_f32 v103, v82, v80
    v_cvt_pk_bf16_f32 v102, v86, v84
    v_cvt_pk_bf16_f32 v101, v90, v88
    v_cvt_pk_bf16_f32 v100, v94, v92
    v_cvt_pk_bf16_f32 v107, v83, v81
    v_cvt_pk_bf16_f32 v106, v87, v85
    v_cvt_pk_bf16_f32 v105, v91, v89
    v_cvt_pk_bf16_f32 v104, v95, v93
    ds_write_b128 v148, v[100:103] offset:0
    ds_write_b128 v148, v[104:107] offset:128
    s_waitcnt lgkmcnt(0)
    s_barrier
    ds_read_b128 v[108:111], v150 offset:0
    ds_read_b128 v[112:115], v150 offset:4096
    s_waitcnt lgkmcnt(1)
    buffer_store_dwordx4 v[108:111], v151, s[8:11], s74 offen sc0 sc1
    s_waitcnt lgkmcnt(0)
    buffer_store_dwordx4 v[112:115], v151, s[8:11], s75 offen sc0 sc1
    v_mov_b32 v253, 0
    buffer_load_dword v251, v253, s[28:31], 0 offen sc0 sc1
    s_waitcnt vmcnt(20)
    v_lshlrev_b32 v44, 16, v120
    v_and_b32 v45, s70, v120
    v_lshlrev_b32 v46, 16, v121
    v_and_b32 v47, s70, v121
    v_lshlrev_b32 v48, 16, v122
    v_and_b32 v49, s70, v122
    v_lshlrev_b32 v50, 16, v123
    v_and_b32 v51, s70, v123
    v_lshlrev_b32 v52, 16, v124
    v_and_b32 v53, s70, v124
    v_lshlrev_b32 v54, 16, v125
    v_and_b32 v55, s70, v125
    v_lshlrev_b32 v56, 16, v126
    v_and_b32 v57, s70, v126
    v_lshlrev_b32 v58, 16, v127
    v_and_b32 v59, s70, v127
    v_lshlrev_b32 v60, 16, v128
    v_and_b32 v61, s70, v128
    v_lshlrev_b32 v62, 16, v129
    v_and_b32 v63, s70, v129
    v_lshlrev_b32 v64, 16, v130
    v_and_b32 v65, s70, v130
    v_pk_mul_f32 v[80:81], v[50:51], v[68:69]
    v_pk_mul_f32 v[82:83], v[52:53], v[68:69]
    v_pk_mul_f32 v[84:85], v[54:55], v[68:69]
    v_pk_mul_f32 v[86:87], v[56:57], v[68:69]
    v_pk_mul_f32 v[88:89], v[58:59], v[68:69]
    v_pk_mul_f32 v[90:91], v[60:61], v[68:69]
    v_pk_mul_f32 v[92:93], v[62:63], v[68:69]
    v_pk_mul_f32 v[94:95], v[64:65], v[68:69]
    v_pk_fma_f32 v[80:81], v[48:49], v[70:71], v[80:81]
    v_pk_fma_f32 v[82:83], v[50:51], v[70:71], v[82:83]
    v_pk_fma_f32 v[84:85], v[52:53], v[70:71], v[84:85]
    v_pk_fma_f32 v[86:87], v[54:55], v[70:71], v[86:87]
    v_pk_fma_f32 v[88:89], v[56:57], v[70:71], v[88:89]
    v_pk_fma_f32 v[90:91], v[58:59], v[70:71], v[90:91]
    v_pk_fma_f32 v[92:93], v[60:61], v[70:71], v[92:93]
    v_pk_fma_f32 v[94:95], v[62:63], v[70:71], v[94:95]
    v_pk_fma_f32 v[80:81], v[46:47], v[72:73], v[80:81]
    v_pk_fma_f32 v[82:83], v[48:49], v[72:73], v[82:83]
    v_pk_fma_f32 v[84:85], v[50:51], v[72:73], v[84:85]
    v_pk_fma_f32 v[86:87], v[52:53], v[72:73], v[86:87]
    v_pk_fma_f32 v[88:89], v[54:55], v[72:73], v[88:89]
    v_pk_fma_f32 v[90:91], v[56:57], v[72:73], v[90:91]
    v_pk_fma_f32 v[92:93], v[58:59], v[72:73], v[92:93]
    v_pk_fma_f32 v[94:95], v[60:61], v[72:73], v[94:95]
    v_pk_fma_f32 v[80:81], v[44:45], v[74:75], v[80:81]
    v_pk_fma_f32 v[82:83], v[46:47], v[74:75], v[82:83]
    v_pk_fma_f32 v[84:85], v[48:49], v[74:75], v[84:85]
    v_pk_fma_f32 v[86:87], v[50:51], v[74:75], v[86:87]
    v_pk_fma_f32 v[88:89], v[52:53], v[74:75], v[88:89]
    v_pk_fma_f32 v[90:91], v[54:55], v[74:75], v[90:91]
    v_pk_fma_f32 v[92:93], v[56:57], v[74:75], v[92:93]
    v_pk_fma_f32 v[94:95], v[58:59], v[74:75], v[94:95]
    s_waitcnt vmcnt(12)
    v_lshlrev_b32 v96, 16, v131
    v_and_b32 v97, s70, v131
    v_pk_mul_f32 v[80:81], v[80:81], v[96:97]
    v_lshlrev_b32 v98, 16, v132
    v_and_b32 v99, s70, v132
    v_pk_mul_f32 v[82:83], v[82:83], v[98:99]
    v_lshlrev_b32 v96, 16, v133
    v_and_b32 v97, s70, v133
    v_pk_mul_f32 v[84:85], v[84:85], v[96:97]
    v_lshlrev_b32 v98, 16, v134
    v_and_b32 v99, s70, v134
    v_pk_mul_f32 v[86:87], v[86:87], v[98:99]
    v_lshlrev_b32 v96, 16, v135
    v_and_b32 v97, s70, v135
    v_pk_mul_f32 v[88:89], v[88:89], v[96:97]
    v_lshlrev_b32 v98, 16, v136
    v_and_b32 v99, s70, v136
    v_pk_mul_f32 v[90:91], v[90:91], v[98:99]
    v_lshlrev_b32 v96, 16, v137
    v_and_b32 v97, s70, v137
    v_pk_mul_f32 v[92:93], v[92:93], v[96:97]
    v_lshlrev_b32 v98, 16, v138
    v_and_b32 v99, s70, v138
    v_pk_mul_f32 v[94:95], v[94:95], v[98:99]
    v_cvt_pk_bf16_f32 v103, v82, v80
    v_cvt_pk_bf16_f32 v102, v86, v84
    v_cvt_pk_bf16_f32 v101, v90, v88
    v_cvt_pk_bf16_f32 v100, v94, v92
    v_cvt_pk_bf16_f32 v107, v83, v81
    v_cvt_pk_bf16_f32 v106, v87, v85
    v_cvt_pk_bf16_f32 v105, v91, v89
    v_cvt_pk_bf16_f32 v104, v95, v93
    ds_write_b128 v148, v[100:103] offset:8192
    ds_write_b128 v148, v[104:107] offset:8320
    s_waitcnt vmcnt(0)
    v_readfirstlane_b32 s12, v251
    s_nop 3
    s_cmp_lg_u32 s12, 0
    s_cbranch_scc1 L_f_nok_2
    s_mov_b32 s13, 40000
L_f_nspin_3:
    v_mov_b32 v253, 0
    buffer_load_dword v251, v253, s[28:31], 0 offen sc0 sc1
    s_waitcnt vmcnt(0)
    v_readfirstlane_b32 s12, v251
    s_nop 3
    s_cmp_lg_u32 s12, 0
    s_cbranch_scc1 L_f_nok_2
    s_sub_u32 s13, s13, 1
    s_cmp_eq_u32 s13, 0
    s_cbranch_scc1 L_bail
    s_branch L_f_nspin_3
L_f_nok_2:
    s_waitcnt lgkmcnt(0)
    s_barrier
    s_cmp_lg_u32 s3, 0
    s_cbranch_scc1 L_f_flag_4
    s_lshl_b32 s97, s2, 4
    s_add_u32 s97, s97, 24281088
    s_mov_b64 exec, 0xff
    v_mov_b32 v252, s12
    v_lshlrev_b32 v253, 12, v0
    buffer_store_dword v252, v253, s[8:11], s97 offen sc0 sc1
    s_mov_b64 exec, -1
L_f_flag_4:
    ds_read_b128 v[140:143], v150 offset:8192
    ds_read_b128 v[144:147], v150 offset:12288
    s_waitcnt lgkmcnt(1)
    buffer_store_dwordx4 v[140:143], v151, s[8:11], s76 offen sc0 sc1
    s_waitcnt lgkmcnt(0)
    buffer_store_dwordx4 v[144:147], v151, s[8:11], s77 offen sc0 sc1
    s_mul_i32 s61, s3, 40
    v_add_u32 v5, s61, v0
    v_lshlrev_b32 v5, 4, v5
    s_and_b32 s61, s2, 7
    s_lshl_b32 s61, s61, 12
    s_add_u32 s61, s61, 24117248
    s_lshl_b32 s62, s5, 2
    v_add_u32 v7, s62, v0
    v_lshlrev_b32 v7, 6, v7
    s_mov_b32 s90, 24215552
    s_lshl_b32 s84, s5, 2
    s_add_u32 s84, s84, s3
    s_mul_i32 s84, s84, 61440
    s_add_u32 s84, s84, 10455040
    s_lshr_b32 s85, s3, 1
    s_mul_i32 s85, s85, 30720
    v_add_u32 v213, 30720, v1
    v_subrev_u32 v214, s85, v213
    v_add_u32 v213, s85, v213
    s_lshl_b32 s80, s2, 2
    s_add_u32 s80, s80, s3
    s_lshl_b32 s81, s80, 12
    s_lshr_b32 s60, s80, 1
    s_lshl_b32 s60, s60, 2
    s_add_u32 s62, s42, s60
    s_addc_u32 s63, s43, 0
    s_load_dword s83, s[62:63], 0
    s_mul_i32 s82, s3, 21248
    v_and_b32 v17, 3, v0
    v_mul_u32_u24 v8, 4160, v17
    v_and_b32 v17, 12, v0
    v_lshl_add_u32 v8, v17, 1, v8
    v_lshl_add_u32 v8, v2, 4, v8
    v_add_u32 v8, s82, v8
    v_lshlrev_b32 v17, 5, v3
    v_sub_u32 v9, 17120, v17
    v_lshl_add_u32 v9, v2, 4, v9
    v_add_u32 v9, s82, v9
    v_sub_u32 v10, 17144, v17
    v_lshlrev_b32 v18, 3, v2
    v_sub_u32 v10, v10, v18
    v_add_u32 v10, s82, v10
    v_lshlrev_b32 v11, 6, v3
    v_lshl_add_u32 v11, v2, 4, v11
    v_add_u32 v11, 84992, v11
    v_lshrrev_b32 v18, 1, v3
    v_mul_u32_u24 v18, 40960, v18
    v_and_b32 v17, 1, v3
    v_lshl_add_u32 v18, v17, 5, v18
    v_lshl_add_u32 v215, v2, 3, v18
    v_lshrrev_b32 v210, 2, v0
    v_and_b32 v211, 3, v0
    v_lshrrev_b32 v212, 5, v0
    v_lshlrev_b32 v212, 1, v212
    v_xor_b32 v211, v211, v212
    v_lshlrev_b32 v211, 4, v211
    v_lshl_add_u32 v210, v210, 6, v211
    s_mul_i32 s82, s3, 21248
    v_add_u32 v16, s82, v1
    v_mov_b32 v12, 0
    v_mov_b32 v13, 0
    v_mov_b32 v14, 0
    v_mov_b32 v15, 0
    s_mov_b64 exec, 0x3fffffff
    ds_write_b128 v16, v[12:15] offset:20736
    s_mov_b64 exec, -1
    v_mul_u32_u24 v19, 4160, v2
    v_lshl_add_u32 v19, v3, 1, v19
    v_add_u32 v19, s82, v19
    v_alignbit_b32 v216, v161, v160, 16
    v_alignbit_b32 v217, v162, v161, 16
    v_alignbit_b32 v218, v163, v162, 16
    v_alignbit_b32 v219, v164, v163, 16
    v_mov_b32 v220, v161
    v_mov_b32 v221, v162
    v_mov_b32 v222, v163
    v_mov_b32 v223, v164
    v_alignbit_b32 v224, v162, v161, 16
    v_alignbit_b32 v225, v163, v162, 16
    v_alignbit_b32 v226, v164, v163, 16
    v_alignbit_b32 v227, v165, v164, 16
    ds_write_b128 v16, v[216:219] offset:32
    ds_write_b128 v16, v[220:223] offset:4192
    ds_write_b128 v16, v[224:227] offset:8352
    ds_write_b128 v16, v[162:165] offset:12512
    v_alignbit_b32 v228, v167, v166, 16
    v_alignbit_b32 v229, v168, v167, 16
    v_alignbit_b32 v230, v169, v168, 16
    v_alignbit_b32 v231, v170, v169, 16
    v_mov_b32 v232, v167
    v_mov_b32 v233, v168
    v_mov_b32 v234, v169
    v_mov_b32 v235, v170
    v_alignbit_b32 v236, v168, v167, 16
    v_alignbit_b32 v237, v169, v168, 16
    v_alignbit_b32 v238, v170, v169, 16
    v_alignbit_b32 v239, v171, v170, 16
    ds_write_b128 v16, v[228:231] offset:1056
    ds_write_b128 v16, v[232:235] offset:5216
    ds_write_b128 v16, v[236:239] offset:9376
    ds_write_b128 v16, v[168:171] offset:13536
    v_alignbit_b32 v216, v173, v172, 16
    v_alignbit_b32 v217, v174, v173, 16
    v_alignbit_b32 v218, v175, v174, 16
    v_alignbit_b32 v219, v176, v175, 16
    v_mov_b32 v220, v173
    v_mov_b32 v221, v174
    v_mov_b32 v222, v175
    v_mov_b32 v223, v176
    v_alignbit_b32 v224, v174, v173, 16
    v_alignbit_b32 v225, v175, v174, 16
    v_alignbit_b32 v226, v176, v175, 16
    v_alignbit_b32 v227, v177, v176, 16
    ds_write_b128 v16, v[216:219] offset:2080
    ds_write_b128 v16, v[220:223] offset:6240
    ds_write_b128 v16, v[224:227] offset:10400
    ds_write_b128 v16, v[174:177] offset:14560
    v_alignbit_b32 v228, v179, v178, 16
    v_alignbit_b32 v229, v180, v179, 16
    v_alignbit_b32 v230, v181, v180, 16
    v_alignbit_b32 v231, v182, v181, 16
    v_mov_b32 v232, v179
    v_mov_b32 v233, v180
    v_mov_b32 v234, v181
    v_mov_b32 v235, v182
    v_alignbit_b32 v236, v180, v179, 16
    v_alignbit_b32 v237, v181, v180, 16
    v_alignbit_b32 v238, v182, v181, 16
    v_alignbit_b32 v239, v183, v182, 16
    ds_write_b128 v16, v[228:231] offset:3104
    ds_write_b128 v16, v[232:235] offset:7264
    ds_write_b128 v16, v[236:239] offset:11424
    ds_write_b128 v16, v[180:183] offset:15584
    ds_write_b16 v19, v208
    v_mov_b32 v13, v215
    s_waitcnt lgkmcnt(0)
    s_bitcmp1_b32 s80, 0
    s_cselect_b32 s60, 0, 16
    s_lshl_b32 s78, s83, s60
    s_and_b32 s78, s78, 0xffff0000
    s_mov_b32 s79, s78
    s_waitcnt vmcnt(0)
    s_barrier
    s_cmp_lg_u32 s3, 0
    s_cbranch_scc1 L_f_flag_5
    s_lshl_b32 s97, s2, 4
    s_add_u32 s97, s97, 24117248
    s_mov_b64 exec, 0xff
    v_mov_b32 v252, s12
    v_lshlrev_b32 v253, 12, v0
    buffer_store_dword v252, v253, s[8:11], s97 offen sc0 sc1
    s_mov_b64 exec, -1
L_f_flag_5:
    s_mul_i32 s62, s3, 56
    v_add_u32 v17, s62, v0
    v_lshlrev_b32 v17, 4, v17
    s_and_b32 s62, s2, 7
    s_lshl_b32 s62, s62, 12
    s_add_u32 s62, s62, 24281088
    s_mov_b32 s96, s62
    s_bfm_b64 exec, 56, 0
    buffer_load_dword v6, v17, s[8:11], s96 offen sc0 sc1
    s_mov_b64 exec, -1
    s_mov_b32 s16, s48
    s_and_b32 s17, s49, 0xffff
    s_mov_b32 s18, 0xc00
    s_mov_b32 s19, 0x00020000
    s_mov_b32 s20, s54
    s_and_b32 s21, s55, 0xffff
    s_mov_b32 s22, 0x280000
    s_mov_b32 s23, 0x00020000
    s_mov_b32 s24, s52
    s_and_b32 s25, s53, 0xffff
    s_mov_b32 s26, 0x500
    s_mov_b32 s27, 0x00020000
    s_and_b32 s40, s3, 1
    s_mul_i32 s70, s5, 12
    s_mul_i32 s71, s3, 3
    s_add_u32 s70, s70, s71
    s_add_u32 s71, s70, s40
    s_lshl_b32 s41, s71, 5
    s_add_u32 s58, s41, 32
    s_mul_i32 s72, s40, 3
    s_add_u32 s73, s70, 2
    s_sub_u32 s73, s73, s72
    s_add_u32 s73, s73, s40
    s_lshl_b32 s59, s73, 5
    s_mul_i32 s74, s5, 6
    s_mul_i32 s75, s3, 3
    s_add_u32 s76, s75, s40
    s_lshr_b32 s76, s76, 1
    s_add_u32 s76, s76, s74
    s_mul_i32 s77, s40, 3
    s_add_u32 s75, s75, 2
    s_sub_u32 s75, s75, s77
    s_lshr_b32 s75, s75, 1
    s_add_u32 s75, s75, s74
    s_xor_b32 s70, s40, 0
    s_lshl_b32 s71, s4, 1
    s_add_u32 s70, s70, s71
    s_mul_i32 s70, s70, 48
    s_add_u32 s52, s70, s76
    s_lshl_b32 s52, s52, 10
    s_add_u32 s52, s52, 16777216
    s_add_u32 s53, s70, s75
    s_lshl_b32 s53, s53, 10
    s_add_u32 s53, s53, 16777216
    s_xor_b32 s70, s40, 1
    s_lshl_b32 s71, s4, 1
    s_add_u32 s70, s70, s71
    s_mul_i32 s70, s70, 48
    s_add_u32 s54, s70, s76
    s_lshl_b32 s54, s54, 10
    s_add_u32 s54, s54, 16777216
    s_add_u32 s55, s70, s75
    s_lshl_b32 s55, s55, 10
    s_add_u32 s55, s55, 16777216
    s_mul_i32 s57, s5, 245760
    s_mul_i32 s70, s3, 61440
    s_add_u32 s57, s57, s70
    s_add_u32 s57, s57, 12582912
    s_add_u32 s48, s57, 46080
    s_mul_i32 s51, s3, 15360
    s_add_u32 s51, s51, 40960
    v_and_b32 v234, 3, v3
    v_cmp_eq_u32 s[32:33], 1, v234
    v_cmp_eq_u32 s[34:35], 2, v234
    v_cmp_eq_u32 s[36:37], 3, v234
    v_lshrrev_b32 v234, 2, v3
    v_cmp_eq_u32 s[38:39], v234, v2
    s_lshl_b32 s70, s3, 7
    s_add_u32 s70, s70, 158720
    v_lshl_add_u32 v234, v3, 3, s70
    s_lshl_b32 s70, s40, 7
    s_add_u32 s70, s70, 158720
    v_lshl_add_u32 v235, v3, 3, s70
    s_lshr_b32 s70, s3, 1
    s_lshl_b32 s70, s70, 4
    s_mul_i32 s71, s5, 80
    s_add_u32 s70, s70, s71
    s_lshl_b32 s42, s70, 1
    s_lshl_b32 s71, s70, 6
    s_add_u32 s71, s71, 117760
    v_lshrrev_b32 v248, 2, v3
    v_lshl_add_u32 v248, v2, 2, v248
    v_lshlrev_b32 v248, 6, v248
    v_lshrrev_b32 v249, 1, v2
    v_xor_b32 v249, s40, v249
    v_lshl_add_u32 v248, v249, 5, v248
    v_and_b32 v249, 3, v3
    v_lshl_add_u32 v248, v249, 3, v248
    v_add_u32 v248, s71, v248
    v_mul_u32_u24 v249, 1280, v3
    v_lshl_add_u32 v249, v2, 3, v249
    s_lshl_b32 s71, s3, 10
    s_add_u32 s71, s71, 0
    v_add_u32 v250, s71, v1
    s_lshl_b32 s46, s4, 1
    s_add_u32 s46, s46, s40
    s_mul_i32 s46, s46, 20480
    s_add_u32 s46, s46, s42
    s_cmp_ge_u32 s3, 2
    s_cselect_b32 s43, 0x7ffff000, s46
    s_add_u32 s91, s81, 0
    s_add_u32 s92, s82, 16640
    s_lshl_b32 s62, s3, 10
    s_add_u32 s93, s62, 6291456
    s_add_u32 s94, s62, 84992
    s_and_b32 s62, s80, 0xfffffffe
    s_lshl_b32 s95, s62, 6
    s_and_b32 s62, s3, 1
    s_mul_i32 s63, s62, 655360
    s_add_u32 s95, s95, s63
    s_add_u32 s95, s95, 3145728
    s_lshl_b32 s62, s62, 11
    s_lshr_b32 s63, s3, 1
    s_lshl_b32 s63, s63, 13
    s_add_u32 s44, s62, s63
    s_add_u32 s44, s44, 101376
    v_lshrrev_b32 v216, 3, v0
    v_mul_u32_u24 v216, 40960, v216
    v_and_b32 v217, 7, v0
    v_lshl_add_u32 v216, v217, 4, v216
    v_lshrrev_b32 v217, 1, v3
    v_lshlrev_b32 v217, 7, v217
    v_and_b32 v218, 1, v3
    v_lshl_add_u32 v217, v218, 5, v217
    v_lshl_add_u32 v217, v2, 3, v217
    s_and_b32 s62, s3, 1
    s_lshl_b32 s62, s62, 6
    s_add_u32 s62, s62, s63
    s_add_u32 s62, s62, 101376
    v_add_u32 v217, s62, v217
    s_waitcnt vmcnt(0)
    s_bfm_b64 exec, 56, 0
    v_cmp_ne_u32 vcc, s12, v6
    s_mov_b64 exec, -1
    s_cbranch_vccz L_f_pok_6
    s_mov_b32 s13, 40000
    s_waitcnt vmcnt(0)
    s_bfm_b64 exec, 56, 0
    buffer_load_dword v6, v17, s[8:11], s96 offen sc0 sc1
L_f_pspin_7:
    buffer_load_dword v16, v17, s[8:11], s96 offen sc0 sc1
    s_waitcnt vmcnt(1)
    v_cmp_ne_u32 vcc, s12, v6
    s_cbranch_vccz L_f_pok_6x
    buffer_load_dword v6, v17, s[8:11], s96 offen sc0 sc1
    s_waitcnt vmcnt(1)
    v_cmp_ne_u32 vcc, s12, v16
    s_cbranch_vccz L_f_pok_6x
    s_sub_u32 s13, s13, 1
    s_cmp_eq_u32 s13, 0
    s_cbranch_scc0 L_f_pspin_7
    s_mov_b64 exec, -1
    s_branch L_bail
L_f_pok_6x:
    s_mov_b64 exec, -1
    s_waitcnt vmcnt(0)
L_f_pok_6:
    s_barrier
    s_add_u32 m0, s92, 2048
    s_add_u32 s62, s91, 2048
    buffer_load_dwordx4 v1, s[8:11], s62 offen sc1 lds
    s_add_u32 m0, s92, 3072
    s_add_u32 s62, s91, 3072
    buffer_load_dwordx4 v1, s[8:11], s62 offen sc1 lds
    s_add_u32 m0, s44, 0
    s_add_u32 s62, s95, 0
    buffer_load_dwordx4 v216, s[8:11], s62 offen sc1 lds
    s_add_u32 m0, s44, 1024
    s_add_u32 s62, s95, 327680
    buffer_load_dwordx4 v216, s[8:11], s62 offen sc1 lds
    s_add_u32 m0, s94, 0
    s_add_u32 s62, s93, 0
    buffer_load_dwordx4 v1, s[8:11], s62 offen sc1 lds
    s_add_u32 m0, s94, 8192
    s_add_u32 s62, s93, 8192
    buffer_load_dwordx4 v1, s[8:11], s62 offen sc1 lds
    s_waitcnt vmcnt(4)
    ds_read_b64 v[32:33], v8 offset:0
    ds_read_b64 v[34:35], v8 offset:8
    ds_read_b128 v[96:99], v9 offset:3584
    ds_read_b128 v[100:103], v9 offset:3072
    ds_read_b128 v[104:107], v9 offset:2560
    ds_read_b128 v[108:111], v9 offset:2048
    ds_read_b64 v[36:37], v8 offset:512
    ds_read_b64 v[38:39], v8 offset:520
    ds_read_b64 v[40:41], v8 offset:1024
    ds_read_b64 v[42:43], v8 offset:1032
    ds_read_b64 v[44:45], v8 offset:1536
    ds_read_b64 v[46:47], v8 offset:1544
    s_waitcnt lgkmcnt(4)
    v_mfma_f32_16x16x32_bf16 v[128:131], v[32:35], v[96:99], 0
    ds_read_b64 v[64:65], v8 offset:64
    ds_read_b64 v[66:67], v8 offset:72
    v_mfma_f32_16x16x32_bf16 v[132:135], v[32:35], v[100:103], 0
    ds_read_b128 v[160:163], v9 offset:3648
    ds_read_b128 v[164:167], v9 offset:3136
    v_mfma_f32_16x16x32_bf16 v[136:139], v[32:35], v[104:107], 0
    ds_read_b128 v[168:171], v9 offset:2624
    ds_read_b128 v[172:175], v9 offset:2112
    v_mfma_f32_16x16x32_bf16 v[140:143], v[32:35], v[108:111], 0
    ds_read_b64 v[68:69], v8 offset:576
    ds_read_b64 v[70:71], v8 offset:584
    v_mfma_f32_16x16x32_bf16 v[132:135], v[36:39], v[96:99], v[132:135]
    ds_read_b64 v[72:73], v8 offset:1088
    ds_read_b64 v[74:75], v8 offset:1096
    v_mfma_f32_16x16x32_bf16 v[136:139], v[36:39], v[100:103], v[136:139]
    ds_read_b64 v[76:77], v8 offset:1600
    ds_read_b64 v[78:79], v8 offset:1608
    v_mfma_f32_16x16x32_bf16 v[140:143], v[36:39], v[104:107], v[140:143]
    s_waitcnt lgkmcnt(12)
    v_mfma_f32_16x16x32_bf16 v[136:139], v[40:43], v[96:99], v[136:139]
    v_mfma_f32_16x16x32_bf16 v[140:143], v[40:43], v[100:103], v[140:143]
    v_mfma_f32_16x16x32_bf16 v[140:143], v[44:47], v[96:99], v[140:143]
    s_waitcnt lgkmcnt(4)
    v_mfma_f32_16x16x32_bf16 v[128:131], v[64:67], v[160:163], v[128:131]
    ds_read_b64 v[32:33], v8 offset:128
    ds_read_b64 v[34:35], v8 offset:136
    v_mfma_f32_16x16x32_bf16 v[132:135], v[64:67], v[164:167], v[132:135]
    ds_read_b128 v[96:99], v9 offset:3712
    ds_read_b128 v[100:103], v9 offset:3200
    v_mfma_f32_16x16x32_bf16 v[136:139], v[64:67], v[168:171], v[136:139]
    ds_read_b128 v[104:107], v9 offset:2688
    ds_read_b128 v[108:111], v9 offset:2176
    v_mfma_f32_16x16x32_bf16 v[140:143], v[64:67], v[172:175], v[140:143]
    ds_read_b64 v[36:37], v8 offset:640
    ds_read_b64 v[38:39], v8 offset:648
    v_mfma_f32_16x16x32_bf16 v[132:135], v[68:71], v[160:163], v[132:135]
    ds_read_b64 v[40:41], v8 offset:1152
    ds_read_b64 v[42:43], v8 offset:1160
    s_add_u32 m0, s94, 4096
    s_add_u32 s62, s93, 4096
    buffer_load_dwordx4 v1, s[8:11], s62 offen sc1 lds
    v_mfma_f32_16x16x32_bf16 v[136:139], v[68:71], v[164:167], v[136:139]
    ds_read_b64 v[44:45], v8 offset:1664
    ds_read_b64 v[46:47], v8 offset:1672
    v_mfma_f32_16x16x32_bf16 v[140:143], v[68:71], v[168:171], v[140:143]
    s_waitcnt lgkmcnt(12)
    v_mfma_f32_16x16x32_bf16 v[136:139], v[72:75], v[160:163], v[136:139]
    v_mfma_f32_16x16x32_bf16 v[140:143], v[72:75], v[164:167], v[140:143]
    v_mfma_f32_16x16x32_bf16 v[140:143], v[76:79], v[160:163], v[140:143]
    s_add_u32 m0, s94, 12288
    s_add_u32 s62, s93, 12288
    buffer_load_dwordx4 v1, s[8:11], s62 offen sc1 lds
    s_waitcnt lgkmcnt(4)
    v_mfma_f32_16x16x32_bf16 v[128:131], v[32:35], v[96:99], v[128:131]
    ds_read_b64 v[64:65], v8 offset:192
    ds_read_b64 v[66:67], v8 offset:200
    v_mfma_f32_16x16x32_bf16 v[132:135], v[32:35], v[100:103], v[132:135]
    ds_read_b128 v[160:163], v9 offset:3776
    ds_read_b128 v[164:167], v9 offset:3264
    v_mfma_f32_16x16x32_bf16 v[136:139], v[32:35], v[104:107], v[136:139]
    ds_read_b128 v[168:171], v9 offset:2752
    ds_read_b128 v[172:175], v9 offset:2240
    v_mfma_f32_16x16x32_bf16 v[140:143], v[32:35], v[108:111], v[140:143]
    ds_read_b64 v[68:69], v8 offset:704
    ds_read_b64 v[70:71], v8 offset:712
    v_mfma_f32_16x16x32_bf16 v[132:135], v[36:39], v[96:99], v[132:135]
    ds_read_b64 v[72:73], v8 offset:1216
    ds_read_b64 v[74:75], v8 offset:1224
    s_add_u32 m0, s44, 4096
    s_add_u32 s62, s95, 1310720
    buffer_load_dwordx4 v216, s[8:11], s62 offen sc1 lds
    v_mfma_f32_16x16x32_bf16 v[136:139], v[36:39], v[100:103], v[136:139]
    ds_read_b64 v[76:77], v8 offset:1728
    ds_read_b64 v[78:79], v8 offset:1736
    v_mfma_f32_16x16x32_bf16 v[140:143], v[36:39], v[104:107], v[140:143]
    s_waitcnt lgkmcnt(12)
    v_mfma_f32_16x16x32_bf16 v[136:139], v[40:43], v[96:99], v[136:139]
    v_mfma_f32_16x16x32_bf16 v[140:143], v[40:43], v[100:103], v[140:143]
    v_mfma_f32_16x16x32_bf16 v[140:143], v[44:47], v[96:99], v[140:143]
    s_add_u32 m0, s44, 5120
    s_add_u32 s62, s95, 1638400
    buffer_load_dwordx4 v216, s[8:11], s62 offen sc1 lds
    s_waitcnt lgkmcnt(4)
    v_mfma_f32_16x16x32_bf16 v[128:131], v[64:67], v[160:163], v[128:131]
    ds_read_b64 v[32:33], v8 offset:256
    ds_read_b64 v[34:35], v8 offset:264
    v_mfma_f32_16x16x32_bf16 v[132:135], v[64:67], v[164:167], v[132:135]
    ds_read_b128 v[96:99], v9 offset:3840
    ds_read_b128 v[100:103], v9 offset:3328
    v_mfma_f32_16x16x32_bf16 v[136:139], v[64:67], v[168:171], v[136:139]
    ds_read_b128 v[104:107], v9 offset:2816
    ds_read_b128 v[108:111], v9 offset:2304
    v_mfma_f32_16x16x32_bf16 v[140:143], v[64:67], v[172:175], v[140:143]
    ds_read_b64 v[36:37], v8 offset:768
    ds_read_b64 v[38:39], v8 offset:776
    v_mfma_f32_16x16x32_bf16 v[132:135], v[68:71], v[160:163], v[132:135]
    ds_read_b64 v[40:41], v8 offset:1280
    ds_read_b64 v[42:43], v8 offset:1288
    v_mfma_f32_16x16x32_bf16 v[136:139], v[68:71], v[164:167], v[136:139]
    ds_read_b64 v[44:45], v8 offset:1792
    ds_read_b64 v[46:47], v8 offset:1800
    v_mfma_f32_16x16x32_bf16 v[140:143], v[68:71], v[168:171], v[140:143]
    s_waitcnt lgkmcnt(12)
    v_mfma_f32_16x16x32_bf16 v[136:139], v[72:75], v[160:163], v[136:139]
    v_mfma_f32_16x16x32_bf16 v[140:143], v[72:75], v[164:167], v[140:143]
    v_mfma_f32_16x16x32_bf16 v[140:143], v[76:79], v[160:163], v[140:143]
    s_waitcnt lgkmcnt(4)
    v_mfma_f32_16x16x32_bf16 v[128:131], v[32:35], v[96:99], v[128:131]
    ds_read_b64 v[64:65], v8 offset:320
    ds_read_b64 v[66:67], v8 offset:328
    v_mfma_f32_16x16x32_bf16 v[132:135], v[32:35], v[100:103], v[132:135]
    ds_read_b128 v[160:163], v9 offset:3904
    ds_read_b128 v[164:167], v9 offset:3392
    v_mfma_f32_16x16x32_bf16 v[136:139], v[32:35], v[104:107], v[136:139]
    ds_read_b128 v[168:171], v9 offset:2880
    ds_read_b128 v[172:175], v9 offset:2368
    v_mfma_f32_16x16x32_bf16 v[140:143], v[32:35], v[108:111], v[140:143]
    ds_read_b64 v[68:69], v8 offset:832
    ds_read_b64 v[70:71], v8 offset:840
    v_mfma_f32_16x16x32_bf16 v[132:135], v[36:39], v[96:99], v[132:135]
    ds_read_b64 v[72:73], v8 offset:1344
    ds_read_b64 v[74:75], v8 offset:1352
    v_mfma_f32_16x16x32_bf16 v[136:139], v[36:39], v[100:103], v[136:139]
    ds_read_b64 v[76:77], v8 offset:1856
    ds_read_b64 v[78:79], v8 offset:1864
    v_mfma_f32_16x16x32_bf16 v[140:143], v[36:39], v[104:107], v[140:143]
    s_waitcnt lgkmcnt(12)
    v_mfma_f32_16x16x32_bf16 v[136:139], v[40:43], v[96:99], v[136:139]
    v_mfma_f32_16x16x32_bf16 v[140:143], v[40:43], v[100:103], v[140:143]
    v_mfma_f32_16x16x32_bf16 v[140:143], v[44:47], v[96:99], v[140:143]
    s_bfm_b64 exec, 40, 0
    buffer_load_dword v6, v5, s[8:11], s61 offen sc0 sc1
    s_mov_b64 exec, -1
    s_waitcnt lgkmcnt(4)
    v_mfma_f32_16x16x32_bf16 v[128:131], v[64:67], v[160:163], v[128:131]
    ds_read_b64 v[32:33], v8 offset:384
    ds_read_b64 v[34:35], v8 offset:392
    v_mfma_f32_16x16x32_bf16 v[132:135], v[64:67], v[164:167], v[132:135]
    ds_read_b128 v[96:99], v9 offset:3968
    ds_read_b128 v[100:103], v9 offset:3456
    v_mfma_f32_16x16x32_bf16 v[136:139], v[64:67], v[168:171], v[136:139]
    ds_read_b128 v[104:107], v9 offset:2944
    ds_read_b128 v[108:111], v9 offset:2432
    v_mfma_f32_16x16x32_bf16 v[140:143], v[64:67], v[172:175], v[140:143]
    ds_read_b64 v[36:37], v8 offset:896
    ds_read_b64 v[38:39], v8 offset:904
    v_mfma_f32_16x16x32_bf16 v[132:135], v[68:71], v[160:163], v[132:135]
    ds_read_b64 v[40:41], v8 offset:1408
    ds_read_b64 v[42:43], v8 offset:1416
    v_mfma_f32_16x16x32_bf16 v[136:139], v[68:71], v[164:167], v[136:139]
    ds_read_b64 v[44:45], v8 offset:1920
    ds_read_b64 v[46:47], v8 offset:1928
    v_mfma_f32_16x16x32_bf16 v[140:143], v[68:71], v[168:171], v[140:143]
    s_waitcnt lgkmcnt(12)
    v_mfma_f32_16x16x32_bf16 v[136:139], v[72:75], v[160:163], v[136:139]
    v_mfma_f32_16x16x32_bf16 v[140:143], v[72:75], v[164:167], v[140:143]
    v_mfma_f32_16x16x32_bf16 v[140:143], v[76:79], v[160:163], v[140:143]
    s_waitcnt lgkmcnt(4)
    v_mfma_f32_16x16x32_bf16 v[128:131], v[32:35], v[96:99], v[128:131]
    ds_read_b64 v[64:65], v8 offset:448
    ds_read_b64 v[66:67], v8 offset:456
    v_mfma_f32_16x16x32_bf16 v[132:135], v[32:35], v[100:103], v[132:135]
    ds_read_b128 v[160:163], v9 offset:4032
    ds_read_b128 v[164:167], v9 offset:3520
    v_mfma_f32_16x16x32_bf16 v[136:139], v[32:35], v[104:107], v[136:139]
    ds_read_b128 v[168:171], v9 offset:3008
    ds_read_b128 v[172:175], v9 offset:2496
    v_mfma_f32_16x16x32_bf16 v[140:143], v[32:35], v[108:111], v[140:143]
    ds_read_b64 v[68:69], v8 offset:960
    ds_read_b64 v[70:71], v8 offset:968
    v_mfma_f32_16x16x32_bf16 v[132:135], v[36:39], v[96:99], v[132:135]
    ds_read_b64 v[72:73], v8 offset:1472
    ds_read_b64 v[74:75], v8 offset:1480
    v_mfma_f32_16x16x32_bf16 v[136:139], v[36:39], v[100:103], v[136:139]
    ds_read_b64 v[76:77], v8 offset:1984
    ds_read_b64 v[78:79], v8 offset:1992
    v_mfma_f32_16x16x32_bf16 v[140:143], v[36:39], v[104:107], v[140:143]
    s_waitcnt lgkmcnt(12)
    v_mfma_f32_16x16x32_bf16 v[136:139], v[40:43], v[96:99], v[136:139]
    v_mfma_f32_16x16x32_bf16 v[140:143], v[40:43], v[100:103], v[140:143]
    v_mfma_f32_16x16x32_bf16 v[140:143], v[44:47], v[96:99], v[140:143]
    s_bfm_b64 exec, 4, 0
    buffer_load_dword v14, v7, s[8:11], s90 offen sc0 sc1
    s_mov_b64 exec, -1
    s_waitcnt vmcnt(1)
    s_bfm_b64 exec, 40, 0
    v_cmp_ne_u32 vcc, s12, v6
    s_mov_b64 exec, -1
    s_cbranch_vccz L_f_pok_8
    s_mov_b32 s13, 40000
L_f_pspin_9:
    s_bfm_b64 exec, 40, 0
    buffer_load_dword v6, v5, s[8:11], s61 offen sc0 sc1
    s_waitcnt vmcnt(0)
    v_cmp_ne_u32 vcc, s12, v6
    s_mov_b64 exec, -1
    s_cbranch_vccz L_f_pok_8
    s_sub_u32 s13, s13, 1
    s_cmp_eq_u32 s13, 0
    s_cbranch_scc1 L_bail
    s_branch L_f_pspin_9
L_f_pok_8:
    s_barrier
    s_waitcnt lgkmcnt(4)
    v_mfma_f32_16x16x32_bf16 v[128:131], v[64:67], v[160:163], v[128:131]
    ds_read_b64 v[32:33], v10 offset:3584
    ds_read_b128 v[40:43], v11 offset:0
    v_mfma_f32_16x16x32_bf16 v[132:135], v[64:67], v[164:167], v[132:135]
    ds_read_b128 v[96:99], v11 offset:8192
    ds_read_b64 v[192:193], v217 offset:0
    v_mfma_f32_16x16x32_bf16 v[136:139], v[64:67], v[168:171], v[136:139]
    ds_read_b64 v[34:35], v10 offset:3072
    ds_read_b128 v[44:47], v11 offset:1024
    v_mfma_f32_16x16x32_bf16 v[140:143], v[64:67], v[172:175], v[140:143]
    ds_read_b128 v[100:103], v11 offset:9216
    ds_read_b64 v[194:195], v217 offset:1024
    v_mfma_f32_16x16x32_bf16 v[132:135], v[68:71], v[160:163], v[132:135]
    ds_read_b64 v[36:37], v10 offset:2560
    ds_read_b128 v[48:51], v11 offset:2048
    s_add_u32 m0, s92, 0
    s_add_u32 s62, s91, 0
    buffer_load_dwordx4 v1, s[8:11], s62 offen sc1 lds
    v_mfma_f32_16x16x32_bf16 v[136:139], v[68:71], v[164:167], v[136:139]
    ds_read_b128 v[104:107], v11 offset:10240
    ds_read_b64 v[196:197], v217 offset:2048
    v_mfma_f32_16x16x32_bf16 v[140:143], v[68:71], v[168:171], v[140:143]
    ds_read_b64 v[38:39], v10 offset:2048
    ds_read_b128 v[52:55], v11 offset:3072
    s_waitcnt lgkmcnt(14)
    v_mfma_f32_16x16x32_bf16 v[136:139], v[72:75], v[160:163], v[136:139]
    ds_read_b128 v[108:111], v11 offset:11264
    ds_read_b64 v[198:199], v217 offset:3072
    v_mfma_f32_16x16x32_bf16 v[140:143], v[72:75], v[164:167], v[140:143]
    v_mfma_f32_16x16x32_bf16 v[140:143], v[76:79], v[160:163], v[140:143]
    s_add_u32 m0, s92, 1024
    s_add_u32 s62, s91, 1024
    buffer_load_dwordx4 v1, s[8:11], s62 offen sc1 lds
    s_waitcnt lgkmcnt(0)
    s_nop 4
    s_mov_b32 s70, 0xffff0000
    s_lshl_b32 s60, s80, 6
    s_add_u32 s60, s60, 7340032
    v_lshlrev_b32 v64, 16, v192
    v_and_b32 v65, s70, v192
    v_lshlrev_b32 v66, 16, v193
    v_and_b32 v67, s70, v193
    v_and_b32 v68, s70, v33
    v_lshlrev_b32 v69, 16, v33
    v_and_b32 v70, s70, v32
    v_lshlrev_b32 v71, 16, v32
    v_pk_fma_f32 v[128:129], v[68:69], s[78:79], v[128:129]
    v_pk_fma_f32 v[130:131], v[70:71], s[78:79], v[130:131]
    v_pk_fma_f32 v[72:73], v[64:65], v[96:97], v[40:41]
    v_pk_fma_f32 v[74:75], v[66:67], v[98:99], v[42:43]
    v_pk_fma_f32 v[64:65], v[72:73], v[128:129], v[64:65]
    v_pk_fma_f32 v[66:67], v[74:75], v[130:131], v[66:67]
    v_cvt_pk_bf16_f32 v76, v64, v65
    v_cvt_pk_bf16_f32 v77, v66, v67
    buffer_store_dwordx2 v[76:77], v13, s[8:11], s60 offen sc0 sc1
    s_add_u32 s60, s60, 327680
    v_lshlrev_b32 v64, 16, v194
    v_and_b32 v65, s70, v194
    v_lshlrev_b32 v66, 16, v195
    v_and_b32 v67, s70, v195
    v_and_b32 v68, s70, v35
    v_lshlrev_b32 v69, 16, v35
    v_and_b32 v70, s70, v34
    v_lshlrev_b32 v71, 16, v34
    v_pk_fma_f32 v[132:133], v[68:69], s[78:79], v[132:133]
    v_pk_fma_f32 v[134:135], v[70:71], s[78:79], v[134:135]
    v_pk_fma_f32 v[72:73], v[64:65], v[100:101], v[44:45]
    v_pk_fma_f32 v[74:75], v[66:67], v[102:103], v[46:47]
    v_pk_fma_f32 v[64:65], v[72:73], v[132:133], v[64:65]
    v_pk_fma_f32 v[66:67], v[74:75], v[134:135], v[66:67]
    v_cvt_pk_bf16_f32 v78, v64, v65
    v_cvt_pk_bf16_f32 v79, v66, v67
    buffer_store_dwordx2 v[78:79], v13, s[8:11], s60 offen sc0 sc1
    s_add_u32 s60, s60, 327680
    v_lshlrev_b32 v64, 16, v196
    v_and_b32 v65, s70, v196
    v_lshlrev_b32 v66, 16, v197
    v_and_b32 v67, s70, v197
    v_and_b32 v68, s70, v37
    v_lshlrev_b32 v69, 16, v37
    v_and_b32 v70, s70, v36
    v_lshlrev_b32 v71, 16, v36
    v_pk_fma_f32 v[136:137], v[68:69], s[78:79], v[136:137]
    v_pk_fma_f32 v[138:139], v[70:71], s[78:79], v[138:139]
    v_pk_fma_f32 v[72:73], v[64:65], v[104:105], v[48:49]
    v_pk_fma_f32 v[74:75], v[66:67], v[106:107], v[50:51]
    v_pk_fma_f32 v[64:65], v[72:73], v[136:137], v[64:65]
    v_pk_fma_f32 v[66:67], v[74:75], v[138:139], v[66:67]
    v_cvt_pk_bf16_f32 v76, v64, v65
    v_cvt_pk_bf16_f32 v77, v66, v67
    buffer_store_dwordx2 v[76:77], v13, s[8:11], s60 offen sc0 sc1
    s_add_u32 s60, s60, 327680
    v_lshlrev_b32 v64, 16, v198
    v_and_b32 v65, s70, v198
    v_lshlrev_b32 v66, 16, v199
    v_and_b32 v67, s70, v199
    v_and_b32 v68, s70, v39
    v_lshlrev_b32 v69, 16, v39
    v_and_b32 v70, s70, v38
    v_lshlrev_b32 v71, 16, v38
    v_pk_fma_f32 v[140:141], v[68:69], s[78:79], v[140:141]
    v_pk_fma_f32 v[142:143], v[70:71], s[78:79], v[142:143]
    v_pk_fma_f32 v[72:73], v[64:65], v[108:109], v[52:53]
    v_pk_fma_f32 v[74:75], v[66:67], v[110:111], v[54:55]
    v_pk_fma_f32 v[64:65], v[72:73], v[140:141], v[64:65]
    v_pk_fma_f32 v[66:67], v[74:75], v[142:143], v[66:67]
    v_cvt_pk_bf16_f32 v78, v64, v65
    v_cvt_pk_bf16_f32 v79, v66, v67
    buffer_store_dwordx2 v[78:79], v13, s[8:11], s60 offen sc0 sc1
    s_waitcnt vmcnt(4)
    ds_read_b64 v[32:33], v8 offset:0
    ds_read_b64 v[34:35], v8 offset:8
    ds_read_b128 v[112:115], v9 offset:1536
    ds_read_b128 v[116:119], v9 offset:1024
    ds_read_b128 v[120:123], v9 offset:512
    ds_read_b128 v[124:127], v9 offset:0
    ds_read_b64 v[36:37], v8 offset:512
    ds_read_b64 v[38:39], v8 offset:520
    ds_read_b128 v[108:111], v9 offset:2048
    ds_read_b64 v[40:41], v8 offset:1024
    ds_read_b64 v[42:43], v8 offset:1032
    ds_read_b128 v[104:107], v9 offset:2560
    s_waitcnt lgkmcnt(0)
    ds_read_b64 v[44:45], v8 offset:1536
    ds_read_b64 v[46:47], v8 offset:1544
    ds_read_b128 v[100:103], v9 offset:3072
    ds_read_b64 v[48:49], v8 offset:2048
    ds_read_b64 v[50:51], v8 offset:2056
    ds_read_b128 v[96:99], v9 offset:3584
    ds_read_b64 v[52:53], v8 offset:2560
    ds_read_b64 v[54:55], v8 offset:2568
    ds_read_b64 v[56:57], v8 offset:3072
    ds_read_b64 v[58:59], v8 offset:3080
    ds_read_b64 v[60:61], v8 offset:3584
    ds_read_b64 v[62:63], v8 offset:3592
    s_bfm_b64 exec, 4, 0
    v_cmp_ne_u32 vcc, s12, v14
    s_mov_b64 exec, -1
    s_cbranch_vccz L_f_pok_10
    s_mov_b32 s13, 40000
L_f_pspin_11:
    s_bfm_b64 exec, 4, 0
    buffer_load_dword v14, v7, s[8:11], s90 offen sc0 sc1
    s_waitcnt vmcnt(0)
    v_cmp_ne_u32 vcc, s12, v14
    s_mov_b64 exec, -1
    s_cbranch_vccz L_f_pok_10
    s_sub_u32 s13, s13, 1
    s_cmp_eq_u32 s13, 0
    s_cbranch_scc1 L_bail
    s_branch L_f_pspin_11
L_f_pok_10:
    v_mfma_f32_16x16x32_bf16 v[144:147], v[32:35], v[112:115], 0
    ds_read_b64 v[64:65], v8 offset:64
    v_mfma_f32_16x16x32_bf16 v[148:151], v[32:35], v[116:119], 0
    ds_read_b64 v[66:67], v8 offset:72
    v_mfma_f32_16x16x32_bf16 v[152:155], v[32:35], v[120:123], 0
    ds_read_b128 v[176:179], v9 offset:1600
    v_mfma_f32_16x16x32_bf16 v[156:159], v[32:35], v[124:127], 0
    ds_read_b128 v[180:183], v9 offset:1088
    buffer_load_dwordx4 a[0:3], v213, s[8:11], s84 offen offset:0 sc1
    v_mfma_f32_16x16x32_bf16 v[144:147], v[36:39], v[108:111], v[144:147]
    ds_read_b128 v[184:187], v9 offset:576
    v_mfma_f32_16x16x32_bf16 v[148:151], v[36:39], v[112:115], v[148:151]
    ds_read_b128 v[188:191], v9 offset:64
    v_mfma_f32_16x16x32_bf16 v[152:155], v[36:39], v[116:119], v[152:155]
    ds_read_b64 v[68:69], v8 offset:576
    v_mfma_f32_16x16x32_bf16 v[156:159], v[36:39], v[120:123], v[156:159]
    ds_read_b64 v[70:71], v8 offset:584
    buffer_load_dwordx4 a[4:7], v213, s[8:11], s84 offen offset:1024 sc1
    v_mfma_f32_16x16x32_bf16 v[144:147], v[40:43], v[104:107], v[144:147]
    ds_read_b128 v[172:175], v9 offset:2112
    v_mfma_f32_16x16x32_bf16 v[148:151], v[40:43], v[108:111], v[148:151]
    ds_read_b64 v[72:73], v8 offset:1088
    v_mfma_f32_16x16x32_bf16 v[152:155], v[40:43], v[112:115], v[152:155]
    ds_read_b64 v[74:75], v8 offset:1096
    v_mfma_f32_16x16x32_bf16 v[156:159], v[40:43], v[116:119], v[156:159]
    ds_read_b128 v[168:171], v9 offset:2624
    buffer_load_dwordx4 a[8:11], v213, s[8:11], s84 offen offset:2048 sc1
    s_add_u32 s84, s84, 3072
    s_waitcnt lgkmcnt(14)
    v_mfma_f32_16x16x32_bf16 v[144:147], v[44:47], v[100:103], v[144:147]
    ds_read_b64 v[76:77], v8 offset:1600
    v_mfma_f32_16x16x32_bf16 v[148:151], v[44:47], v[104:107], v[148:151]
    ds_read_b64 v[78:79], v8 offset:1608
    v_mfma_f32_16x16x32_bf16 v[152:155], v[44:47], v[108:111], v[152:155]
    ds_read_b128 v[164:167], v9 offset:3136
    v_mfma_f32_16x16x32_bf16 v[156:159], v[44:47], v[112:115], v[156:159]
    ds_read_b64 v[80:81], v8 offset:2112
    buffer_load_dwordx4 a[12:15], v213, s[8:11], s84 offen offset:0 sc1
    v_mfma_f32_16x16x32_bf16 v[144:147], v[48:51], v[96:99], v[144:147]
    ds_read_b64 v[82:83], v8 offset:2120
    v_mfma_f32_16x16x32_bf16 v[148:151], v[48:51], v[100:103], v[148:151]
    ds_read_b128 v[160:163], v9 offset:3648
    v_mfma_f32_16x16x32_bf16 v[152:155], v[48:51], v[104:107], v[152:155]
    ds_read_b64 v[84:85], v8 offset:2624
    v_mfma_f32_16x16x32_bf16 v[156:159], v[48:51], v[108:111], v[156:159]
    ds_read_b64 v[86:87], v8 offset:2632
    buffer_load_dwordx4 a[16:19], v213, s[8:11], s84 offen offset:1024 sc1
    s_waitcnt lgkmcnt(14)
    v_mfma_f32_16x16x32_bf16 v[148:151], v[52:55], v[96:99], v[148:151]
    ds_read_b64 v[88:89], v8 offset:3136
    v_mfma_f32_16x16x32_bf16 v[152:155], v[52:55], v[100:103], v[152:155]
    ds_read_b64 v[90:91], v8 offset:3144
    v_mfma_f32_16x16x32_bf16 v[156:159], v[52:55], v[104:107], v[156:159]
    ds_read_b64 v[92:93], v8 offset:3648
    v_mfma_f32_16x16x32_bf16 v[152:155], v[56:59], v[96:99], v[152:155]
    ds_read_b64 v[94:95], v8 offset:3656
    buffer_load_dwordx4 a[20:23], v213, s[8:11], s84 offen offset:2048 sc1
    s_add_u32 s84, s84, 3072
    v_mfma_f32_16x16x32_bf16 v[156:159], v[56:59], v[100:103], v[156:159]
    v_mfma_f32_16x16x32_bf16 v[156:159], v[60:63], v[96:99], v[156:159]
    s_waitcnt lgkmcnt(14)
    v_mfma_f32_16x16x32_bf16 v[144:147], v[64:67], v[176:179], v[144:147]
    ds_read_b64 v[32:33], v8 offset:128
    v_mfma_f32_16x16x32_bf16 v[148:151], v[64:67], v[180:183], v[148:151]
    ds_read_b64 v[34:35], v8 offset:136
    v_mfma_f32_16x16x32_bf16 v[152:155], v[64:67], v[184:187], v[152:155]
    ds_read_b128 v[112:115], v9 offset:1664
    v_mfma_f32_16x16x32_bf16 v[156:159], v[64:67], v[188:191], v[156:159]
    ds_read_b128 v[116:119], v9 offset:1152
    buffer_load_dwordx4 a[24:27], v213, s[8:11], s84 offen offset:0 sc1
    v_mfma_f32_16x16x32_bf16 v[144:147], v[68:71], v[172:175], v[144:147]
    ds_read_b128 v[120:123], v9 offset:640
    v_mfma_f32_16x16x32_bf16 v[148:151], v[68:71], v[176:179], v[148:151]
    ds_read_b128 v[124:127], v9 offset:128
    v_mfma_f32_16x16x32_bf16 v[152:155], v[68:71], v[180:183], v[152:155]
    ds_read_b64 v[36:37], v8 offset:640
    v_mfma_f32_16x16x32_bf16 v[156:159], v[68:71], v[184:187], v[156:159]
    ds_read_b64 v[38:39], v8 offset:648
    buffer_load_dwordx4 a[28:31], v213, s[8:11], s84 offen offset:1024 sc1
    s_waitcnt lgkmcnt(14)
    v_mfma_f32_16x16x32_bf16 v[144:147], v[72:75], v[168:171], v[144:147]
    ds_read_b128 v[108:111], v9 offset:2176
    v_mfma_f32_16x16x32_bf16 v[148:151], v[72:75], v[172:175], v[148:151]
    ds_read_b64 v[40:41], v8 offset:1152
    v_mfma_f32_16x16x32_bf16 v[152:155], v[72:75], v[176:179], v[152:155]
    ds_read_b64 v[42:43], v8 offset:1160
    v_mfma_f32_16x16x32_bf16 v[156:159], v[72:75], v[180:183], v[156:159]
    ds_read_b128 v[104:107], v9 offset:2688
    buffer_load_dwordx4 a[32:35], v213, s[8:11], s84 offen offset:2048 sc1
    s_add_u32 s84, s84, 3072
    v_mfma_f32_16x16x32_bf16 v[144:147], v[76:79], v[164:167], v[144:147]
    ds_read_b64 v[44:45], v8 offset:1664
    v_mfma_f32_16x16x32_bf16 v[148:151], v[76:79], v[168:171], v[148:151]
    ds_read_b64 v[46:47], v8 offset:1672
    v_mfma_f32_16x16x32_bf16 v[152:155], v[76:79], v[172:175], v[152:155]
    ds_read_b128 v[100:103], v9 offset:3200
    v_mfma_f32_16x16x32_bf16 v[156:159], v[76:79], v[176:179], v[156:159]
    ds_read_b64 v[48:49], v8 offset:2176
    buffer_load_dwordx4 a[36:39], v213, s[8:11], s84 offen offset:0 sc1
    s_waitcnt lgkmcnt(14)
    v_mfma_f32_16x16x32_bf16 v[144:147], v[80:83], v[160:163], v[144:147]
    ds_read_b64 v[50:51], v8 offset:2184
    v_mfma_f32_16x16x32_bf16 v[148:151], v[80:83], v[164:167], v[148:151]
    ds_read_b128 v[96:99], v9 offset:3712
    v_mfma_f32_16x16x32_bf16 v[152:155], v[80:83], v[168:171], v[152:155]
    ds_read_b64 v[52:53], v8 offset:2688
    v_mfma_f32_16x16x32_bf16 v[156:159], v[80:83], v[172:175], v[156:159]
    ds_read_b64 v[54:55], v8 offset:2696
    buffer_load_dwordx4 a[40:43], v213, s[8:11], s84 offen offset:1024 sc1
    v_mfma_f32_16x16x32_bf16 v[148:151], v[84:87], v[160:163], v[148:151]
    ds_read_b64 v[56:57], v8 offset:3200
    v_mfma_f32_16x16x32_bf16 v[152:155], v[84:87], v[164:167], v[152:155]
    ds_read_b64 v[58:59], v8 offset:3208
    v_mfma_f32_16x16x32_bf16 v[156:159], v[84:87], v[168:171], v[156:159]
    ds_read_b64 v[60:61], v8 offset:3712
    s_waitcnt lgkmcnt(14)
    v_mfma_f32_16x16x32_bf16 v[152:155], v[88:91], v[160:163], v[152:155]
    ds_read_b64 v[62:63], v8 offset:3720
    buffer_load_dwordx4 a[44:47], v213, s[8:11], s84 offen offset:2048 sc1
    s_add_u32 s84, s84, 3072
    v_mfma_f32_16x16x32_bf16 v[156:159], v[88:91], v[164:167], v[156:159]
    v_mfma_f32_16x16x32_bf16 v[156:159], v[92:95], v[160:163], v[156:159]
    s_waitcnt vmcnt(12)
    s_barrier
    s_cmp_lg_u32 s3, 0
    s_cbranch_scc1 L_f_flag_12
    s_lshl_b32 s97, s2, 4
    s_add_u32 s97, s97, 24150016
    s_mov_b64 exec, 0xff
    v_mov_b32 v252, s12
    v_lshlrev_b32 v253, 12, v0
    buffer_store_dword v252, v253, s[8:11], s97 offen sc0 sc1
    s_mov_b64 exec, -1
L_f_flag_12:
    s_waitcnt lgkmcnt(14)
    v_mfma_f32_16x16x32_bf16 v[144:147], v[32:35], v[112:115], v[144:147]
    ds_read_b64 v[64:65], v8 offset:192
    v_mfma_f32_16x16x32_bf16 v[148:151], v[32:35], v[116:119], v[148:151]
    ds_read_b64 v[66:67], v8 offset:200
    v_mfma_f32_16x16x32_bf16 v[152:155], v[32:35], v[120:123], v[152:155]
    ds_read_b128 v[176:179], v9 offset:1728
    v_mfma_f32_16x16x32_bf16 v[156:159], v[32:35], v[124:127], v[156:159]
    ds_read_b128 v[180:183], v9 offset:1216
    buffer_load_dwordx4 a[48:51], v213, s[8:11], s84 offen offset:0 sc1
    v_mfma_f32_16x16x32_bf16 v[144:147], v[36:39], v[108:111], v[144:147]
    ds_read_b128 v[184:187], v9 offset:704
    v_mfma_f32_16x16x32_bf16 v[148:151], v[36:39], v[112:115], v[148:151]
    ds_read_b128 v[188:191], v9 offset:192
    v_mfma_f32_16x16x32_bf16 v[152:155], v[36:39], v[116:119], v[152:155]
    ds_read_b64 v[68:69], v8 offset:704
    v_mfma_f32_16x16x32_bf16 v[156:159], v[36:39], v[120:123], v[156:159]
    ds_read_b64 v[70:71], v8 offset:712
    buffer_load_dwordx4 a[52:55], v213, s[8:11], s84 offen offset:1024 sc1
    s_waitcnt lgkmcnt(14)
    v_mfma_f32_16x16x32_bf16 v[144:147], v[40:43], v[104:107], v[144:147]
    ds_read_b128 v[172:175], v9 offset:2240
    v_mfma_f32_16x16x32_bf16 v[148:151], v[40:43], v[108:111], v[148:151]
    ds_read_b64 v[72:73], v8 offset:1216
    v_mfma_f32_16x16x32_bf16 v[152:155], v[40:43], v[112:115], v[152:155]
    ds_read_b64 v[74:75], v8 offset:1224
    v_mfma_f32_16x16x32_bf16 v[156:159], v[40:43], v[116:119], v[156:159]
    ds_read_b128 v[168:171], v9 offset:2752
    buffer_load_dwordx4 a[56:59], v213, s[8:11], s84 offen offset:2048 sc1
    s_add_u32 s84, s84, 3072
    v_mfma_f32_16x16x32_bf16 v[144:147], v[44:47], v[100:103], v[144:147]
    ds_read_b64 v[76:77], v8 offset:1728
    v_mfma_f32_16x16x32_bf16 v[148:151], v[44:47], v[104:107], v[148:151]
    ds_read_b64 v[78:79], v8 offset:1736
    v_mfma_f32_16x16x32_bf16 v[152:155], v[44:47], v[108:111], v[152:155]
    ds_read_b128 v[164:167], v9 offset:3264
    v_mfma_f32_16x16x32_bf16 v[156:159], v[44:47], v[112:115], v[156:159]
    ds_read_b64 v[80:81], v8 offset:2240
    buffer_load_dwordx4 a[60:63], v213, s[8:11], s84 offen offset:0 sc1
    s_waitcnt lgkmcnt(14)
    v_mfma_f32_16x16x32_bf16 v[144:147], v[48:51], v[96:99], v[144:147]
    ds_read_b64 v[82:83], v8 offset:2248
    v_mfma_f32_16x16x32_bf16 v[148:151], v[48:51], v[100:103], v[148:151]
    ds_read_b128 v[160:163], v9 offset:3776
    v_mfma_f32_16x16x32_bf16 v[152:155], v[48:51], v[104:107], v[152:155]
    ds_read_b64 v[84:85], v8 offset:2752
    v_mfma_f32_16x16x32_bf16 v[156:159], v[48:51], v[108:111], v[156:159]
    ds_read_b64 v[86:87], v8 offset:2760
    buffer_load_dwordx4 a[64:67], v213, s[8:11], s84 offen offset:1024 sc1
    v_mfma_f32_16x16x32_bf16 v[148:151], v[52:55], v[96:99], v[148:151]
    ds_read_b64 v[88:89], v8 offset:3264
    v_mfma_f32_16x16x32_bf16 v[152:155], v[52:55], v[100:103], v[152:155]
    ds_read_b64 v[90:91], v8 offset:3272
    v_mfma_f32_16x16x32_bf16 v[156:159], v[52:55], v[104:107], v[156:159]
    ds_read_b64 v[92:93], v8 offset:3776
    s_waitcnt lgkmcnt(14)
    v_mfma_f32_16x16x32_bf16 v[152:155], v[56:59], v[96:99], v[152:155]
    ds_read_b64 v[94:95], v8 offset:3784
    buffer_load_dwordx4 a[68:71], v213, s[8:11], s84 offen offset:2048 sc1
    s_add_u32 s84, s84, 3072
    v_mfma_f32_16x16x32_bf16 v[156:159], v[56:59], v[100:103], v[156:159]
    v_mfma_f32_16x16x32_bf16 v[156:159], v[60:63], v[96:99], v[156:159]
    s_mul_i32 s62, s5, 5
    s_lshr_b32 s62, s62, 2
    s_lshl_b32 s62, s62, 3
    v_add_u32 v14, s62, v0
    v_lshlrev_b32 v14, 6, v14
    s_mov_b32 s91, 24223744
    s_bfm_b64 exec, 16, 0
    buffer_load_dword v15, v14, s[8:11], s91 offen sc0 sc1
    s_mov_b64 exec, -1
    s_waitcnt lgkmcnt(14)
    v_mfma_f32_16x16x32_bf16 v[144:147], v[64:67], v[176:179], v[144:147]
    ds_read_b64 v[32:33], v8 offset:256
    v_mfma_f32_16x16x32_bf16 v[148:151], v[64:67], v[180:183], v[148:151]
    ds_read_b64 v[34:35], v8 offset:264
    v_mfma_f32_16x16x32_bf16 v[152:155], v[64:67], v[184:187], v[152:155]
    ds_read_b128 v[112:115], v9 offset:1792
    v_mfma_f32_16x16x32_bf16 v[156:159], v[64:67], v[188:191], v[156:159]
    ds_read_b128 v[116:119], v9 offset:1280
    buffer_load_dwordx4 a[72:75], v213, s[8:11], s84 offen offset:0 sc1
    v_mfma_f32_16x16x32_bf16 v[144:147], v[68:71], v[172:175], v[144:147]
    ds_read_b128 v[120:123], v9 offset:768
    v_mfma_f32_16x16x32_bf16 v[148:151], v[68:71], v[176:179], v[148:151]
    ds_read_b128 v[124:127], v9 offset:256
    v_mfma_f32_16x16x32_bf16 v[152:155], v[68:71], v[180:183], v[152:155]
    ds_read_b64 v[36:37], v8 offset:768
    v_mfma_f32_16x16x32_bf16 v[156:159], v[68:71], v[184:187], v[156:159]
    ds_read_b64 v[38:39], v8 offset:776
    buffer_load_dwordx4 a[76:79], v213, s[8:11], s84 offen offset:1024 sc1
    s_waitcnt lgkmcnt(14)
    v_mfma_f32_16x16x32_bf16 v[144:147], v[72:75], v[168:171], v[144:147]
    ds_read_b128 v[108:111], v9 offset:2304
    v_mfma_f32_16x16x32_bf16 v[148:151], v[72:75], v[172:175], v[148:151]
    ds_read_b64 v[40:41], v8 offset:1280
    v_mfma_f32_16x16x32_bf16 v[152:155], v[72:75], v[176:179], v[152:155]
    ds_read_b64 v[42:43], v8 offset:1288
    v_mfma_f32_16x16x32_bf16 v[156:159], v[72:75], v[180:183], v[156:159]
    ds_read_b128 v[104:107], v9 offset:2816
    buffer_load_dwordx4 a[80:83], v213, s[8:11], s84 offen offset:2048 sc1
    s_add_u32 s84, s84, 3072
    v_mfma_f32_16x16x32_bf16 v[144:147], v[76:79], v[164:167], v[144:147]
    ds_read_b64 v[44:45], v8 offset:1792
    v_mfma_f32_16x16x32_bf16 v[148:151], v[76:79], v[168:171], v[148:151]
    ds_read_b64 v[46:47], v8 offset:1800
    v_mfma_f32_16x16x32_bf16 v[152:155], v[76:79], v[172:175], v[152:155]
    ds_read_b128 v[100:103], v9 offset:3328
    v_mfma_f32_16x16x32_bf16 v[156:159], v[76:79], v[176:179], v[156:159]
    ds_read_b64 v[48:49], v8 offset:2304
    buffer_load_dwordx4 a[84:87], v213, s[8:11], s84 offen offset:0 sc1
    s_waitcnt lgkmcnt(14)
    v_mfma_f32_16x16x32_bf16 v[144:147], v[80:83], v[160:163], v[144:147]
    ds_read_b64 v[50:51], v8 offset:2312
    v_mfma_f32_16x16x32_bf16 v[148:151], v[80:83], v[164:167], v[148:151]
    ds_read_b128 v[96:99], v9 offset:3840
    v_mfma_f32_16x16x32_bf16 v[152:155], v[80:83], v[168:171], v[152:155]
    ds_read_b64 v[52:53], v8 offset:2816
    v_mfma_f32_16x16x32_bf16 v[156:159], v[80:83], v[172:175], v[156:159]
    ds_read_b64 v[54:55], v8 offset:2824
    buffer_load_dwordx4 a[88:91], v213, s[8:11], s84 offen offset:1024 sc1
    v_mfma_f32_16x16x32_bf16 v[148:151], v[84:87], v[160:163], v[148:151]
    ds_read_b64 v[56:57], v8 offset:3328
    v_mfma_f32_16x16x32_bf16 v[152:155], v[84:87], v[164:167], v[152:155]
    ds_read_b64 v[58:59], v8 offset:3336
    v_mfma_f32_16x16x32_bf16 v[156:159], v[84:87], v[168:171], v[156:159]
    ds_read_b64 v[60:61], v8 offset:3840
    s_waitcnt lgkmcnt(14)
    v_mfma_f32_16x16x32_bf16 v[152:155], v[88:91], v[160:163], v[152:155]
    ds_read_b64 v[62:63], v8 offset:3848
    buffer_load_dwordx4 a[92:95], v213, s[8:11], s84 offen offset:2048 sc1
    s_add_u32 s84, s84, 3072
    v_mfma_f32_16x16x32_bf16 v[156:159], v[88:91], v[164:167], v[156:159]
    v_mfma_f32_16x16x32_bf16 v[156:159], v[92:95], v[160:163], v[156:159]
    s_waitcnt vmcnt(6)
    s_bfm_b64 exec, 16, 0
    v_cmp_ne_u32 vcc, s12, v15
    s_mov_b64 exec, -1
    s_cbranch_vccz L_f_pok_13
    s_mov_b32 s13, 40000
L_f_pspin_14:
    s_bfm_b64 exec, 16, 0
    buffer_load_dword v15, v14, s[8:11], s91 offen sc0 sc1
    s_waitcnt vmcnt(0)
    v_cmp_ne_u32 vcc, s12, v15
    s_mov_b64 exec, -1
    s_cbranch_vccz L_f_pok_13
    s_sub_u32 s13, s13, 1
    s_cmp_eq_u32 s13, 0
    s_cbranch_scc1 L_bail
    s_branch L_f_pspin_14
L_f_pok_13:
    s_mul_i32 s62, s5, 3
    v_add_u32 v14, s62, v0
    v_lshlrev_b32 v14, 6, v14
    s_mov_b32 s91, 24313856
    s_bfm_b64 exec, 3, 0
    buffer_load_dword v15, v14, s[8:11], s91 offen sc0 sc1
    s_mov_b64 exec, -1
    s_waitcnt lgkmcnt(14)
    v_mfma_f32_16x16x32_bf16 v[144:147], v[32:35], v[112:115], v[144:147]
    ds_read_b64 v[64:65], v8 offset:320
    v_mfma_f32_16x16x32_bf16 v[148:151], v[32:35], v[116:119], v[148:151]
    ds_read_b64 v[66:67], v8 offset:328
    v_mfma_f32_16x16x32_bf16 v[152:155], v[32:35], v[120:123], v[152:155]
    ds_read_b128 v[176:179], v9 offset:1856
    v_mfma_f32_16x16x32_bf16 v[156:159], v[32:35], v[124:127], v[156:159]
    ds_read_b128 v[180:183], v9 offset:1344
    buffer_load_dwordx4 a[96:99], v213, s[8:11], s84 offen offset:0 sc1
    v_mfma_f32_16x16x32_bf16 v[144:147], v[36:39], v[108:111], v[144:147]
    ds_read_b128 v[184:187], v9 offset:832
    v_mfma_f32_16x16x32_bf16 v[148:151], v[36:39], v[112:115], v[148:151]
    ds_read_b128 v[188:191], v9 offset:320
    v_mfma_f32_16x16x32_bf16 v[152:155], v[36:39], v[116:119], v[152:155]
    ds_read_b64 v[68:69], v8 offset:832
    v_mfma_f32_16x16x32_bf16 v[156:159], v[36:39], v[120:123], v[156:159]
    ds_read_b64 v[70:71], v8 offset:840
    buffer_load_dwordx4 a[100:103], v213, s[8:11], s84 offen offset:1024 sc1
    s_waitcnt lgkmcnt(14)
    v_mfma_f32_16x16x32_bf16 v[144:147], v[40:43], v[104:107], v[144:147]
    ds_read_b128 v[172:175], v9 offset:2368
    v_mfma_f32_16x16x32_bf16 v[148:151], v[40:43], v[108:111], v[148:151]
    ds_read_b64 v[72:73], v8 offset:1344
    v_mfma_f32_16x16x32_bf16 v[152:155], v[40:43], v[112:115], v[152:155]
    ds_read_b64 v[74:75], v8 offset:1352
    v_mfma_f32_16x16x32_bf16 v[156:159], v[40:43], v[116:119], v[156:159]
    ds_read_b128 v[168:171], v9 offset:2880
    buffer_load_dwordx4 a[104:107], v213, s[8:11], s84 offen offset:2048 sc1
    s_add_u32 s84, s84, 3072
    v_mfma_f32_16x16x32_bf16 v[144:147], v[44:47], v[100:103], v[144:147]
    ds_read_b64 v[76:77], v8 offset:1856
    v_mfma_f32_16x16x32_bf16 v[148:151], v[44:47], v[104:107], v[148:151]
    ds_read_b64 v[78:79], v8 offset:1864
    v_mfma_f32_16x16x32_bf16 v[152:155], v[44:47], v[108:111], v[152:155]
    ds_read_b128 v[164:167], v9 offset:3392
    v_mfma_f32_16x16x32_bf16 v[156:159], v[44:47], v[112:115], v[156:159]
    ds_read_b64 v[80:81], v8 offset:2368
    buffer_load_dwordx4 a[108:111], v213, s[8:11], s84 offen offset:0 sc1
    s_waitcnt lgkmcnt(14)
    v_mfma_f32_16x16x32_bf16 v[144:147], v[48:51], v[96:99], v[144:147]
    ds_read_b64 v[82:83], v8 offset:2376
    v_mfma_f32_16x16x32_bf16 v[148:151], v[48:51], v[100:103], v[148:151]
    ds_read_b128 v[160:163], v9 offset:3904
    v_mfma_f32_16x16x32_bf16 v[152:155], v[48:51], v[104:107], v[152:155]
    ds_read_b64 v[84:85], v8 offset:2880
    v_mfma_f32_16x16x32_bf16 v[156:159], v[48:51], v[108:111], v[156:159]
    ds_read_b64 v[86:87], v8 offset:2888
    buffer_load_dwordx4 a[112:115], v213, s[8:11], s84 offen offset:1024 sc1
    v_mfma_f32_16x16x32_bf16 v[148:151], v[52:55], v[96:99], v[148:151]
    ds_read_b64 v[88:89], v8 offset:3392
    v_mfma_f32_16x16x32_bf16 v[152:155], v[52:55], v[100:103], v[152:155]
    ds_read_b64 v[90:91], v8 offset:3400
    v_mfma_f32_16x16x32_bf16 v[156:159], v[52:55], v[104:107], v[156:159]
    ds_read_b64 v[92:93], v8 offset:3904
    s_waitcnt lgkmcnt(14)
    v_mfma_f32_16x16x32_bf16 v[152:155], v[56:59], v[96:99], v[152:155]
    ds_read_b64 v[94:95], v8 offset:3912
    buffer_load_dwordx4 a[116:119], v213, s[8:11], s84 offen offset:2048 sc1
    s_add_u32 s84, s84, 3072
    v_mfma_f32_16x16x32_bf16 v[156:159], v[56:59], v[100:103], v[156:159]
    v_mfma_f32_16x16x32_bf16 v[156:159], v[60:63], v[96:99], v[156:159]
    s_waitcnt lgkmcnt(14)
    v_mfma_f32_16x16x32_bf16 v[144:147], v[64:67], v[176:179], v[144:147]
    ds_read_b64 v[32:33], v8 offset:384
    v_mfma_f32_16x16x32_bf16 v[148:151], v[64:67], v[180:183], v[148:151]
    ds_read_b64 v[34:35], v8 offset:392
    v_mfma_f32_16x16x32_bf16 v[152:155], v[64:67], v[184:187], v[152:155]
    ds_read_b128 v[112:115], v9 offset:1920
    v_mfma_f32_16x16x32_bf16 v[156:159], v[64:67], v[188:191], v[156:159]
    ds_read_b128 v[116:119], v9 offset:1408
    buffer_load_dwordx4 a[120:123], v214, s[8:11], s84 offen offset:0 sc1
    v_mfma_f32_16x16x32_bf16 v[144:147], v[68:71], v[172:175], v[144:147]
    ds_read_b128 v[120:123], v9 offset:896
    v_mfma_f32_16x16x32_bf16 v[148:151], v[68:71], v[176:179], v[148:151]
    ds_read_b128 v[124:127], v9 offset:384
    v_mfma_f32_16x16x32_bf16 v[152:155], v[68:71], v[180:183], v[152:155]
    ds_read_b64 v[36:37], v8 offset:896
    v_mfma_f32_16x16x32_bf16 v[156:159], v[68:71], v[184:187], v[156:159]
    ds_read_b64 v[38:39], v8 offset:904
    buffer_load_dwordx4 a[124:127], v214, s[8:11], s84 offen offset:1024 sc1
    s_waitcnt lgkmcnt(14)
    v_mfma_f32_16x16x32_bf16 v[144:147], v[72:75], v[168:171], v[144:147]
    ds_read_b128 v[108:111], v9 offset:2432
    v_mfma_f32_16x16x32_bf16 v[148:151], v[72:75], v[172:175], v[148:151]
    ds_read_b64 v[40:41], v8 offset:1408
    v_mfma_f32_16x16x32_bf16 v[152:155], v[72:75], v[176:179], v[152:155]
    ds_read_b64 v[42:43], v8 offset:1416
    v_mfma_f32_16x16x32_bf16 v[156:159], v[72:75], v[180:183], v[156:159]
    ds_read_b128 v[104:107], v9 offset:2944
    buffer_load_dwordx4 a[128:131], v214, s[8:11], s84 offen offset:2048 sc1
    s_add_u32 s84, s84, 3072
    v_mfma_f32_16x16x32_bf16 v[144:147], v[76:79], v[164:167], v[144:147]
    ds_read_b64 v[44:45], v8 offset:1920
    v_mfma_f32_16x16x32_bf16 v[148:151], v[76:79], v[168:171], v[148:151]
    ds_read_b64 v[46:47], v8 offset:1928
    v_mfma_f32_16x16x32_bf16 v[152:155], v[76:79], v[172:175], v[152:155]
    ds_read_b128 v[100:103], v9 offset:3456
    v_mfma_f32_16x16x32_bf16 v[156:159], v[76:79], v[176:179], v[156:159]
    ds_read_b64 v[48:49], v8 offset:2432
    buffer_load_dwordx4 a[132:135], v214, s[8:11], s84 offen offset:0 sc1
    s_waitcnt lgkmcnt(14)
    v_mfma_f32_16x16x32_bf16 v[144:147], v[80:83], v[160:163], v[144:147]
    ds_read_b64 v[50:51], v8 offset:2440
    v_mfma_f32_16x16x32_bf16 v[148:151], v[80:83], v[164:167], v[148:151]
    ds_read_b128 v[96:99], v9 offset:3968
    v_mfma_f32_16x16x32_bf16 v[152:155], v[80:83], v[168:171], v[152:155]
    ds_read_b64 v[52:53], v8 offset:2944
    v_mfma_f32_16x16x32_bf16 v[156:159], v[80:83], v[172:175], v[156:159]
    ds_read_b64 v[54:55], v8 offset:2952
    buffer_load_dwordx4 a[136:139], v214, s[8:11], s84 offen offset:1024 sc1
    v_mfma_f32_16x16x32_bf16 v[148:151], v[84:87], v[160:163], v[148:151]
    ds_read_b64 v[56:57], v8 offset:3456
    v_mfma_f32_16x16x32_bf16 v[152:155], v[84:87], v[164:167], v[152:155]
    ds_read_b64 v[58:59], v8 offset:3464
    v_mfma_f32_16x16x32_bf16 v[156:159], v[84:87], v[168:171], v[156:159]
    ds_read_b64 v[60:61], v8 offset:3968
    s_waitcnt lgkmcnt(14)
    v_mfma_f32_16x16x32_bf16 v[152:155], v[88:91], v[160:163], v[152:155]
    ds_read_b64 v[62:63], v8 offset:3976
    buffer_load_dwordx4 a[140:143], v214, s[8:11], s84 offen offset:2048 sc1
    s_add_u32 s84, s84, 3072
    v_mfma_f32_16x16x32_bf16 v[156:159], v[88:91], v[164:167], v[156:159]
    v_mfma_f32_16x16x32_bf16 v[156:159], v[92:95], v[160:163], v[156:159]
    s_waitcnt vmcnt(12)
    s_bfm_b64 exec, 3, 0
    v_cmp_ne_u32 vcc, s12, v15
    s_mov_b64 exec, -1
    s_cbranch_vccz L_f_pok_15
    s_mov_b32 s13, 40000
L_f_pspin_16:
    s_bfm_b64 exec, 3, 0
    buffer_load_dword v15, v14, s[8:11], s91 offen sc0 sc1
    s_waitcnt vmcnt(0)
    v_cmp_ne_u32 vcc, s12, v15
    s_mov_b64 exec, -1
    s_cbranch_vccz L_f_pok_15
    s_sub_u32 s13, s13, 1
    s_cmp_eq_u32 s13, 0
    s_cbranch_scc1 L_bail
    s_branch L_f_pspin_16
L_f_pok_15:
    s_mul_i32 s90, s3, 40
    v_add_u32 v5, s90, v0
    v_lshlrev_b32 v5, 4, v5
    s_and_b32 s90, s2, 7
    s_lshl_b32 s90, s90, 12
    s_add_u32 s90, s90, 24150016
    s_bfm_b64 exec, 40, 0
    buffer_load_dword v6, v5, s[8:11], s90 offen sc0 sc1
    s_mov_b64 exec, -1
    s_waitcnt lgkmcnt(14)
    v_mfma_f32_16x16x32_bf16 v[144:147], v[32:35], v[112:115], v[144:147]
    ds_read_b64 v[64:65], v8 offset:448
    v_mfma_f32_16x16x32_bf16 v[148:151], v[32:35], v[116:119], v[148:151]
    ds_read_b64 v[66:67], v8 offset:456
    v_mfma_f32_16x16x32_bf16 v[152:155], v[32:35], v[120:123], v[152:155]
    ds_read_b128 v[176:179], v9 offset:1984
    v_mfma_f32_16x16x32_bf16 v[156:159], v[32:35], v[124:127], v[156:159]
    ds_read_b128 v[180:183], v9 offset:1472
    buffer_load_dwordx4 a[144:147], v214, s[8:11], s84 offen offset:0 sc1
    v_mfma_f32_16x16x32_bf16 v[144:147], v[36:39], v[108:111], v[144:147]
    ds_read_b128 v[184:187], v9 offset:960
    v_mfma_f32_16x16x32_bf16 v[148:151], v[36:39], v[112:115], v[148:151]
    ds_read_b128 v[188:191], v9 offset:448
    v_mfma_f32_16x16x32_bf16 v[152:155], v[36:39], v[116:119], v[152:155]
    ds_read_b64 v[68:69], v8 offset:960
    v_mfma_f32_16x16x32_bf16 v[156:159], v[36:39], v[120:123], v[156:159]
    ds_read_b64 v[70:71], v8 offset:968
    buffer_load_dwordx4 a[148:151], v214, s[8:11], s84 offen offset:1024 sc1
    s_waitcnt lgkmcnt(14)
    v_mfma_f32_16x16x32_bf16 v[144:147], v[40:43], v[104:107], v[144:147]
    ds_read_b128 v[172:175], v9 offset:2496
    v_mfma_f32_16x16x32_bf16 v[148:151], v[40:43], v[108:111], v[148:151]
    ds_read_b64 v[72:73], v8 offset:1472
    v_mfma_f32_16x16x32_bf16 v[152:155], v[40:43], v[112:115], v[152:155]
    ds_read_b64 v[74:75], v8 offset:1480
    v_mfma_f32_16x16x32_bf16 v[156:159], v[40:43], v[116:119], v[156:159]
    ds_read_b128 v[168:171], v9 offset:3008
    buffer_load_dwordx4 a[152:155], v214, s[8:11], s84 offen offset:2048 sc1
    s_add_u32 s84, s84, 3072
    v_mfma_f32_16x16x32_bf16 v[144:147], v[44:47], v[100:103], v[144:147]
    ds_read_b64 v[76:77], v8 offset:1984
    v_mfma_f32_16x16x32_bf16 v[148:151], v[44:47], v[104:107], v[148:151]
    ds_read_b64 v[78:79], v8 offset:1992
    v_mfma_f32_16x16x32_bf16 v[152:155], v[44:47], v[108:111], v[152:155]
    ds_read_b128 v[164:167], v9 offset:3520
    v_mfma_f32_16x16x32_bf16 v[156:159], v[44:47], v[112:115], v[156:159]
    ds_read_b64 v[80:81], v8 offset:2496
    buffer_load_dwordx4 a[156:159], v214, s[8:11], s84 offen offset:0 sc1
    s_waitcnt lgkmcnt(14)
    v_mfma_f32_16x16x32_bf16 v[144:147], v[48:51], v[96:99], v[144:147]
    ds_read_b64 v[82:83], v8 offset:2504
    v_mfma_f32_16x16x32_bf16 v[148:151], v[48:51], v[100:103], v[148:151]
    ds_read_b128 v[160:163], v9 offset:4032
    v_mfma_f32_16x16x32_bf16 v[152:155], v[48:51], v[104:107], v[152:155]
    ds_read_b64 v[84:85], v8 offset:3008
    v_mfma_f32_16x16x32_bf16 v[156:159], v[48:51], v[108:111], v[156:159]
    ds_read_b64 v[86:87], v8 offset:3016
    buffer_load_dwordx4 a[160:163], v214, s[8:11], s84 offen offset:1024 sc1
    v_mfma_f32_16x16x32_bf16 v[148:151], v[52:55], v[96:99], v[148:151]
    ds_read_b64 v[88:89], v8 offset:3520
    v_mfma_f32_16x16x32_bf16 v[152:155], v[52:55], v[100:103], v[152:155]
    ds_read_b64 v[90:91], v8 offset:3528
    v_mfma_f32_16x16x32_bf16 v[156:159], v[52:55], v[104:107], v[156:159]
    ds_read_b64 v[92:93], v8 offset:4032
    s_waitcnt lgkmcnt(14)
    v_mfma_f32_16x16x32_bf16 v[152:155], v[56:59], v[96:99], v[152:155]
    ds_read_b64 v[94:95], v8 offset:4040
    buffer_load_dwordx4 a[164:167], v214, s[8:11], s84 offen offset:2048 sc1
    s_add_u32 s84, s84, 3072
    v_mfma_f32_16x16x32_bf16 v[156:159], v[56:59], v[100:103], v[156:159]
    v_mfma_f32_16x16x32_bf16 v[156:159], v[60:63], v[96:99], v[156:159]
    s_waitcnt vmcnt(6)
    s_bfm_b64 exec, 40, 0
    v_cmp_ne_u32 vcc, s12, v6
    s_mov_b64 exec, -1
    s_cbranch_vccz L_f_pok_17
    s_mov_b32 s13, 40000
L_f_pspin_18:
    s_bfm_b64 exec, 40, 0
    buffer_load_dword v6, v5, s[8:11], s90 offen sc0 sc1
    s_waitcnt vmcnt(0)
    v_cmp_ne_u32 vcc, s12, v6
    s_mov_b64 exec, -1
    s_cbranch_vccz L_f_pok_17
    s_sub_u32 s13, s13, 1
    s_cmp_eq_u32 s13, 0
    s_cbranch_scc1 L_bail
    s_branch L_f_pspin_18
L_f_pok_17:
    s_barrier
    s_waitcnt lgkmcnt(14)
    v_mfma_f32_16x16x32_bf16 v[144:147], v[64:67], v[176:179], v[144:147]
    ds_read_b64 v[32:33], v10 offset:1536
    v_mfma_f32_16x16x32_bf16 v[148:151], v[64:67], v[180:183], v[148:151]
    ds_read_b128 v[40:43], v11 offset:4096
    s_add_u32 s87, s4, 0
    s_mul_i32 s87, s87, 40960
    s_lshl_b32 s88, s3, 11
    s_add_u32 s87, s87, s88
    s_add_u32 s87, s87, 7340032
    s_add_u32 s88, s88, 117760
    s_add_u32 m0, s88, 0
    s_add_u32 s89, s87, 0
    buffer_load_dwordx4 v210, s[8:11], s89 offen sc1 lds
    v_mfma_f32_16x16x32_bf16 v[152:155], v[64:67], v[184:187], v[152:155]
    ds_read_b128 v[96:99], v11 offset:12288
    v_mfma_f32_16x16x32_bf16 v[156:159], v[64:67], v[188:191], v[156:159]
    ds_read_b64 v[200:201], v217 offset:4096
    buffer_load_dwordx4 v210, s[8:11], s89 offen offset:1024 sc1 lds
    v_mfma_f32_16x16x32_bf16 v[144:147], v[68:71], v[172:175], v[144:147]
    ds_read_b64 v[34:35], v10 offset:1024
    v_mfma_f32_16x16x32_bf16 v[148:151], v[68:71], v[176:179], v[148:151]
    ds_read_b128 v[44:47], v11 offset:5120
    s_add_u32 m0, s88, 8192
    s_add_u32 s89, s87, 8192
    buffer_load_dwordx4 v210, s[8:11], s89 offen sc1 lds
    v_mfma_f32_16x16x32_bf16 v[152:155], v[68:71], v[180:183], v[152:155]
    ds_read_b128 v[100:103], v11 offset:13312
    v_mfma_f32_16x16x32_bf16 v[156:159], v[68:71], v[184:187], v[156:159]
    ds_read_b64 v[202:203], v217 offset:5120
    buffer_load_dwordx4 v210, s[8:11], s89 offen offset:1024 sc1 lds
    s_waitcnt lgkmcnt(14)
    v_mfma_f32_16x16x32_bf16 v[144:147], v[72:75], v[168:171], v[144:147]
    ds_read_b64 v[36:37], v10 offset:512
    v_mfma_f32_16x16x32_bf16 v[148:151], v[72:75], v[172:175], v[148:151]
    ds_read_b128 v[48:51], v11 offset:6144
    s_add_u32 m0, s88, 16384
    s_add_u32 s89, s87, 16384
    buffer_load_dwordx4 v210, s[8:11], s89 offen sc1 lds
    v_mfma_f32_16x16x32_bf16 v[152:155], v[72:75], v[176:179], v[152:155]
    ds_read_b128 v[104:107], v11 offset:14336
    v_mfma_f32_16x16x32_bf16 v[156:159], v[72:75], v[180:183], v[156:159]
    ds_read_b64 v[204:205], v217 offset:6144
    buffer_load_dwordx4 v210, s[8:11], s89 offen offset:1024 sc1 lds
    v_mfma_f32_16x16x32_bf16 v[144:147], v[76:79], v[164:167], v[144:147]
    ds_read_b64 v[38:39], v10 offset:0
    v_mfma_f32_16x16x32_bf16 v[148:151], v[76:79], v[168:171], v[148:151]
    ds_read_b128 v[52:55], v11 offset:7168
    s_add_u32 m0, s88, 24576
    s_add_u32 s89, s87, 24576
    buffer_load_dwordx4 v210, s[8:11], s89 offen sc1 lds
    v_mfma_f32_16x16x32_bf16 v[152:155], v[76:79], v[172:175], v[152:155]
    ds_read_b128 v[108:111], v11 offset:15360
    v_mfma_f32_16x16x32_bf16 v[156:159], v[76:79], v[176:179], v[156:159]
    ds_read_b64 v[206:207], v217 offset:7168
    buffer_load_dwordx4 v210, s[8:11], s89 offen offset:1024 sc1 lds
    s_waitcnt lgkmcnt(14)
    v_mfma_f32_16x16x32_bf16 v[144:147], v[80:83], v[160:163], v[144:147]
    v_mfma_f32_16x16x32_bf16 v[148:151], v[80:83], v[164:167], v[148:151]
    s_add_u32 m0, s88, 32768
    s_add_u32 s89, s87, 32768
    buffer_load_dwordx4 v210, s[8:11], s89 offen sc1 lds
    v_mfma_f32_16x16x32_bf16 v[152:155], v[80:83], v[168:171], v[152:155]
    v_mfma_f32_16x16x32_bf16 v[156:159], v[80:83], v[172:175], v[156:159]
    buffer_load_dwordx4 v210, s[8:11], s89 offen offset:1024 sc1 lds
    v_mfma_f32_16x16x32_bf16 v[148:151], v[84:87], v[160:163], v[148:151]
    v_mfma_f32_16x16x32_bf16 v[152:155], v[84:87], v[164:167], v[152:155]
    v_mfma_f32_16x16x32_bf16 v[156:159], v[84:87], v[168:171], v[156:159]
    s_waitcnt lgkmcnt(14)
    v_mfma_f32_16x16x32_bf16 v[152:155], v[88:91], v[160:163], v[152:155]
    v_mfma_f32_16x16x32_bf16 v[156:159], v[88:91], v[164:167], v[156:159]
    v_mfma_f32_16x16x32_bf16 v[156:159], v[92:95], v[160:163], v[156:159]
    s_waitcnt lgkmcnt(0)
    s_mov_b32 s70, 0xffff0000
    s_lshl_b32 s60, s80, 6
    s_add_u32 s60, s60, 8650752
    v_lshlrev_b32 v64, 16, v200
    v_and_b32 v65, s70, v200
    v_lshlrev_b32 v66, 16, v201
    v_and_b32 v67, s70, v201
    v_and_b32 v68, s70, v33
    v_lshlrev_b32 v69, 16, v33
    v_and_b32 v70, s70, v32
    v_lshlrev_b32 v71, 16, v32
    v_pk_fma_f32 v[144:145], v[68:69], s[78:79], v[144:145]
    v_pk_fma_f32 v[146:147], v[70:71], s[78:79], v[146:147]
    v_pk_fma_f32 v[72:73], v[64:65], v[96:97], v[40:41]
    v_pk_fma_f32 v[74:75], v[66:67], v[98:99], v[42:43]
    v_pk_fma_f32 v[64:65], v[72:73], v[144:145], v[64:65]
    v_pk_fma_f32 v[66:67], v[74:75], v[146:147], v[66:67]
    v_cvt_pk_bf16_f32 v76, v64, v65
    v_cvt_pk_bf16_f32 v77, v66, v67
    buffer_store_dwordx2 v[76:77], v13, s[8:11], s60 offen sc0 sc1
    s_add_u32 s60, s60, 327680
    v_lshlrev_b32 v64, 16, v202
    v_and_b32 v65, s70, v202
    v_lshlrev_b32 v66, 16, v203
    v_and_b32 v67, s70, v203
    v_and_b32 v68, s70, v35
    v_lshlrev_b32 v69, 16, v35
    v_and_b32 v70, s70, v34
    v_lshlrev_b32 v71, 16, v34
    v_pk_fma_f32 v[148:149], v[68:69], s[78:79], v[148:149]
    v_pk_fma_f32 v[150:151], v[70:71], s[78:79], v[150:151]
    v_pk_fma_f32 v[72:73], v[64:65], v[100:101], v[44:45]
    v_pk_fma_f32 v[74:75], v[66:67], v[102:103], v[46:47]
    v_pk_fma_f32 v[64:65], v[72:73], v[148:149], v[64:65]
    v_pk_fma_f32 v[66:67], v[74:75], v[150:151], v[66:67]
    v_cvt_pk_bf16_f32 v78, v64, v65
    v_cvt_pk_bf16_f32 v79, v66, v67
    buffer_store_dwordx2 v[78:79], v13, s[8:11], s60 offen sc0 sc1
    s_add_u32 s60, s60, 327680
    v_lshlrev_b32 v64, 16, v204
    v_and_b32 v65, s70, v204
    v_lshlrev_b32 v66, 16, v205
    v_and_b32 v67, s70, v205
    v_and_b32 v68, s70, v37
    v_lshlrev_b32 v69, 16, v37
    v_and_b32 v70, s70, v36
    v_lshlrev_b32 v71, 16, v36
    v_pk_fma_f32 v[152:153], v[68:69], s[78:79], v[152:153]
    v_pk_fma_f32 v[154:155], v[70:71], s[78:79], v[154:155]
    v_pk_fma_f32 v[72:73], v[64:65], v[104:105], v[48:49]
    v_pk_fma_f32 v[74:75], v[66:67], v[106:107], v[50:51]
    v_pk_fma_f32 v[64:65], v[72:73], v[152:153], v[64:65]
    v_pk_fma_f32 v[66:67], v[74:75], v[154:155], v[66:67]
    v_cvt_pk_bf16_f32 v76, v64, v65
    v_cvt_pk_bf16_f32 v77, v66, v67
    buffer_store_dwordx2 v[76:77], v13, s[8:11], s60 offen sc0 sc1
    s_add_u32 s60, s60, 327680
    v_lshlrev_b32 v64, 16, v206
    v_and_b32 v65, s70, v206
    v_lshlrev_b32 v66, 16, v207
    v_and_b32 v67, s70, v207
    v_and_b32 v68, s70, v39
    v_lshlrev_b32 v69, 16, v39
    v_and_b32 v70, s70, v38
    v_lshlrev_b32 v71, 16, v38
    v_pk_fma_f32 v[156:157], v[68:69], s[78:79], v[156:157]
    v_pk_fma_f32 v[158:159], v[70:71], s[78:79], v[158:159]
    v_pk_fma_f32 v[72:73], v[64:65], v[108:109], v[52:53]
    v_pk_fma_f32 v[74:75], v[66:67], v[110:111], v[54:55]
    v_pk_fma_f32 v[64:65], v[72:73], v[156:157], v[64:65]
    v_pk_fma_f32 v[66:67], v[74:75], v[158:159], v[66:67]
    v_cvt_pk_bf16_f32 v78, v64, v65
    v_cvt_pk_bf16_f32 v79, v66, v67
    buffer_store_dwordx2 v[78:79], v13, s[8:11], s60 offen sc0 sc1
    v_lshlrev_b32 v62, 4, v2
    v_lshlrev_b32 v63, 3, v2
    v_lshrrev_b32 v20, 2, v3
    v_lshl_add_u32 v20, v2, 3, v20
    v_lshlrev_b32 v20, 6, v20
    v_and_b32 v21, 3, v3
    v_lshl_add_u32 v20, v21, 3, v20
    v_and_b32 v21, 1, v2
    v_xor_b32 v21, s40, v21
    s_lshr_b32 s66, s3, 1
    s_mul_i32 s66, s66, 20480
    v_lshl_add_u32 v4, v21, 5, v20
    v_xor_b32 v21, 1, v21
    v_lshl_add_u32 v5, v21, 5, v20
    s_add_u32 s67, s66, 117760
    s_sub_u32 s68, 117760, s66
    v_add_u32 v6, s68, v4
    v_add_u32 v7, s68, v5
    v_add_u32 v4, s67, v4
    v_add_u32 v5, s67, v5
    v_mov_b32 v8, 0x3f803f80
    v_mov_b32 v9, 0x3f803f80
    v_mov_b32 v10, 0x3f803f80
    v_mov_b32 v11, 0x3f803f80
    s_mov_b32 s72, 0xbdd2d3e8
    s_mov_b32 s73, 0xbdd2d3e8
    v_mov_b32 v152, 0xc0135761
    v_mov_b32 v153, 0xc0135761
    v_mov_b32 v154, 1.0
    v_mov_b32 v155, 1.0
    s_lshl_b32 s77, s40, 3
    v_add_u32 v142, s77, v1
    v_add_u32 v251, 49152, v1
    v_lshrrev_b32 v210, 2, v0
    v_and_b32 v211, 3, v0
    v_lshrrev_b32 v212, 5, v0
    v_lshlrev_b32 v212, 1, v212
    v_xor_b32 v211, v211, v212
    v_lshlrev_b32 v211, 4, v211
    v_lshl_add_u32 v210, v210, 6, v211
    s_waitcnt vmcnt(4)
    s_barrier
    s_branch L_p2
L_helper:
    s_sub_u32 s60, s2, 160
    s_waitcnt lgkmcnt(0)
    s_add_u32 s58, s58, 0
    s_addc_u32 s59, s59, 0
    s_mov_b32 s8, s58
    s_and_b32 s9, s59, 0xffff
    s_mov_b32 s10, 0x2000000
    s_mov_b32 s11, 0x00020000
    s_mov_b32 s28, s56
    s_and_b32 s29, s57, 0xffff
    s_mov_b32 s30, 0x100
    s_mov_b32 s31, 0x00020000
    s_mov_b32 s16, s46
    s_and_b32 s17, s47, 0xffff
    s_mov_b32 s18, 0x1e0000
    s_mov_b32 s19, 0x00020000
    s_mov_b32 s20, s50
    s_and_b32 s21, s51, 0xffff
    s_mov_b32 s22, 0x1e0000
    s_mov_b32 s23, 0x00020000
    s_mov_b32 s24, s32
    s_and_b32 s25, s33, 0xffff
    s_mov_b32 s26, 0x280000
    s_mov_b32 s27, 0x00020000
    v_lshrrev_b32 v4, 3, v0
    v_and_b32 v5, 7, v0
    v_bfe_u32 v6, v0, 4, 1
    s_and_b32 s61, s3, 1
    s_lshl_b32 s61, s61, 1
    v_or_b32 v6, s61, v6
    v_lshlrev_b32 v6, 1, v6
    v_xor_b32 v5, v5, v6
    v_lshlrev_b32 v5, 4, v5
    s_lshl_b32 s66, s3, 10
    s_sub_u32 s45, s60, 16
    s_cmp_lt_u32 s60, 80
    s_cselect_b32 s45, 127, s45
    s_cmp_lt_u32 s60, 64
    s_cselect_b32 s45, s60, s45
    s_lshr_b32 s69, s45, 3
    s_and_b32 s70, s45, 7
    v_mul_u32_u24 v11, 1280, v4
    v_add_u32 v11, v11, v5
    s_mul_i32 s71, s70, 245760
    s_lshl_b32 s72, s69, 7
    s_add_u32 s71, s71, s72
    s_mul_i32 s72, s3, 10240
    s_add_u32 s71, s71, s72
    v_mov_b32 v253, 0
    s_cmp_ge_u32 s60, 64
    s_cbranch_scc1 L_f_wpath_19
    s_lshl_b32 s67, s60, 5
    s_lshl_b32 s68, s3, 3
    s_add_u32 s67, s67, s68
    v_add_u32 v8, s67, v2
    v_mul_u32_u24 v9, 1280, v8
    v_lshl_add_u32 v9, v3, 4, v9
    v_add_u32 v10, 5120, v9
    buffer_load_dwordx4 v[32:35], v9, s[24:27], 0 offen offset:0 nt
    buffer_load_dwordx4 v[36:39], v9, s[24:27], 0 offen offset:256 nt
    buffer_load_dwordx4 v[40:43], v9, s[24:27], 0 offen offset:512 nt
    buffer_load_dwordx4 v[44:47], v9, s[24:27], 0 offen offset:768 nt
    buffer_load_dwordx4 v[48:51], v9, s[24:27], 0 offen offset:1024 nt
    buffer_load_dwordx4 v[52:55], v10, s[24:27], 0 offen offset:0 nt
    buffer_load_dwordx4 v[56:59], v10, s[24:27], 0 offen offset:256 nt
    buffer_load_dwordx4 v[60:63], v10, s[24:27], 0 offen offset:512 nt
    buffer_load_dwordx4 v[64:67], v10, s[24:27], 0 offen offset:768 nt
    buffer_load_dwordx4 v[68:71], v10, s[24:27], 0 offen offset:1024 nt
    s_waitcnt vmcnt(0)
    buffer_load_dword v251, v253, s[28:31], 0 offen sc0 sc1
    s_mov_b32 s73, 0x3f803f80
    s_lshl_b32 s67, s3, 3
    v_add_u32 v12, s67, v2
    v_mul_u32_u24 v12, 1312, v12
    v_lshl_add_u32 v12, v3, 4, v12
    ds_write_b128 v12, v[32:35] offset:0
    ds_write_b128 v12, v[36:39] offset:256
    ds_write_b128 v12, v[40:43] offset:512
    ds_write_b128 v12, v[44:47] offset:768
    ds_write_b128 v12, v[48:51] offset:1024
    ds_write_b128 v12, v[52:55] offset:5248
    ds_write_b128 v12, v[56:59] offset:5504
    ds_write_b128 v12, v[60:63] offset:5760
    ds_write_b128 v12, v[64:67] offset:6016
    ds_write_b128 v12, v[68:71] offset:6272
    s_mov_b32 s74, 0xffff0000
    s_mov_b32 s75, 0x3acccccd
    s_waitcnt lgkmcnt(0)
    s_barrier
    v_lshrrev_b32 v13, 2, v3
    v_lshl_add_u32 v13, v2, 3, v13
    v_mul_u32_u24 v13, 1312, v13
    v_and_b32 v14, 3, v3
    v_lshl_add_u32 v13, v14, 3, v13
    s_mul_i32 s67, s3, 320
    v_add_u32 v13, s67, v13
    v_lshlrev_b32 v14, 6, v3
    v_lshl_add_u32 v14, v2, 4, v14
    s_mul_i32 s76, s60, 40960
    s_mul_i32 s77, s3, 10240
    s_add_u32 s76, s76, s77
    s_add_u32 s76, s76, 3145728
    ds_read_b64_tr_b16 v[80:81], v13 offset:0
    ds_read_b64_tr_b16 v[82:83], v13 offset:5248
    ds_read_b64_tr_b16 v[84:85], v13 offset:32
    ds_read_b64_tr_b16 v[86:87], v13 offset:5280
    ds_read_b64_tr_b16 v[88:89], v13 offset:64
    ds_read_b64_tr_b16 v[90:91], v13 offset:5312
    ds_read_b64_tr_b16 v[92:93], v13 offset:96
    ds_read_b64_tr_b16 v[94:95], v13 offset:5344
    ds_read_b64_tr_b16 v[96:97], v13 offset:128
    ds_read_b64_tr_b16 v[98:99], v13 offset:5376
    s_waitcnt lgkmcnt(8)
    s_add_u32 s77, s76, 0
    buffer_store_dwordx4 v[80:83], v14, s[8:11], s77 offen offset:0 sc0 sc1
    s_waitcnt lgkmcnt(6)
    s_add_u32 s77, s76, 0
    buffer_store_dwordx4 v[84:87], v14, s[8:11], s77 offen offset:1024 sc0 sc1
    s_waitcnt lgkmcnt(4)
    s_add_u32 s77, s76, 0
    buffer_store_dwordx4 v[88:91], v14, s[8:11], s77 offen offset:2048 sc0 sc1
    s_waitcnt lgkmcnt(2)
    s_add_u32 s77, s76, 0
    buffer_store_dwordx4 v[92:95], v14, s[8:11], s77 offen offset:3072 sc0 sc1
    s_waitcnt lgkmcnt(0)
    s_add_u32 s77, s76, 4096
    buffer_store_dwordx4 v[96:99], v14, s[8:11], s77 offen offset:0 sc0 sc1
    ds_read_b64_tr_b16 v[100:101], v13 offset:160
    ds_read_b64_tr_b16 v[102:103], v13 offset:5408
    ds_read_b64_tr_b16 v[104:105], v13 offset:192
    ds_read_b64_tr_b16 v[106:107], v13 offset:5440
    ds_read_b64_tr_b16 v[108:109], v13 offset:224
    ds_read_b64_tr_b16 v[110:111], v13 offset:5472
    ds_read_b64_tr_b16 v[112:113], v13 offset:256
    ds_read_b64_tr_b16 v[114:115], v13 offset:5504
    ds_read_b64_tr_b16 v[116:117], v13 offset:288
    ds_read_b64_tr_b16 v[118:119], v13 offset:5536
    s_waitcnt lgkmcnt(8)
    s_add_u32 s77, s76, 4096
    buffer_store_dwordx4 v[100:103], v14, s[8:11], s77 offen offset:1024 sc0 sc1
    s_waitcnt lgkmcnt(6)
    s_add_u32 s77, s76, 4096
    buffer_store_dwordx4 v[104:107], v14, s[8:11], s77 offen offset:2048 sc0 sc1
    s_waitcnt lgkmcnt(4)
    s_add_u32 s77, s76, 4096
    buffer_store_dwordx4 v[108:111], v14, s[8:11], s77 offen offset:3072 sc0 sc1
    s_waitcnt lgkmcnt(2)
    s_add_u32 s77, s76, 8192
    buffer_store_dwordx4 v[112:115], v14, s[8:11], s77 offen offset:0 sc0 sc1
    s_waitcnt lgkmcnt(0)
    s_add_u32 s77, s76, 8192
    buffer_store_dwordx4 v[116:119], v14, s[8:11], s77 offen offset:1024 sc0 sc1
    v_mov_b32 v16, 0
    v_mov_b32 v17, 0
    v_mov_b32 v18, 0
    v_mov_b32 v19, 0
    v_mov_b32 v20, 0
    v_mov_b32 v21, 0
    v_mov_b32 v22, 0
    v_mov_b32 v23, 0
    v_dot2_f32_bf16 v16, v32, s73, v16
    v_dot2_f32_bf16 v18, v32, v32, v18
    v_dot2_f32_bf16 v20, v52, s73, v20
    v_dot2_f32_bf16 v22, v52, v52, v22
    v_dot2_f32_bf16 v17, v33, s73, v17
    v_dot2_f32_bf16 v19, v33, v33, v19
    v_dot2_f32_bf16 v21, v53, s73, v21
    v_dot2_f32_bf16 v23, v53, v53, v23
    v_dot2_f32_bf16 v16, v34, s73, v16
    v_dot2_f32_bf16 v18, v34, v34, v18
    v_dot2_f32_bf16 v20, v54, s73, v20
    v_dot2_f32_bf16 v22, v54, v54, v22
    v_dot2_f32_bf16 v17, v35, s73, v17
    v_dot2_f32_bf16 v19, v35, v35, v19
    v_dot2_f32_bf16 v21, v55, s73, v21
    v_dot2_f32_bf16 v23, v55, v55, v23
    v_dot2_f32_bf16 v16, v36, s73, v16
    v_dot2_f32_bf16 v18, v36, v36, v18
    v_dot2_f32_bf16 v20, v56, s73, v20
    v_dot2_f32_bf16 v22, v56, v56, v22
    v_dot2_f32_bf16 v17, v37, s73, v17
    v_dot2_f32_bf16 v19, v37, v37, v19
    v_dot2_f32_bf16 v21, v57, s73, v21
    v_dot2_f32_bf16 v23, v57, v57, v23
    v_dot2_f32_bf16 v16, v38, s73, v16
    v_dot2_f32_bf16 v18, v38, v38, v18
    v_dot2_f32_bf16 v20, v58, s73, v20
    v_dot2_f32_bf16 v22, v58, v58, v22
    v_dot2_f32_bf16 v17, v39, s73, v17
    v_dot2_f32_bf16 v19, v39, v39, v19
    v_dot2_f32_bf16 v21, v59, s73, v21
    v_dot2_f32_bf16 v23, v59, v59, v23
    v_dot2_f32_bf16 v16, v40, s73, v16
    v_dot2_f32_bf16 v18, v40, v40, v18
    v_dot2_f32_bf16 v20, v60, s73, v20
    v_dot2_f32_bf16 v22, v60, v60, v22
    v_dot2_f32_bf16 v17, v41, s73, v17
    v_dot2_f32_bf16 v19, v41, v41, v19
    v_dot2_f32_bf16 v21, v61, s73, v21
    v_dot2_f32_bf16 v23, v61, v61, v23
    v_dot2_f32_bf16 v16, v42, s73, v16
    v_dot2_f32_bf16 v18, v42, v42, v18
    v_dot2_f32_bf16 v20, v62, s73, v20
    v_dot2_f32_bf16 v22, v62, v62, v22
    v_dot2_f32_bf16 v17, v43, s73, v17
    v_dot2_f32_bf16 v19, v43, v43, v19
    v_dot2_f32_bf16 v21, v63, s73, v21
    v_dot2_f32_bf16 v23, v63, v63, v23
    v_dot2_f32_bf16 v16, v44, s73, v16
    v_dot2_f32_bf16 v18, v44, v44, v18
    v_dot2_f32_bf16 v20, v64, s73, v20
    v_dot2_f32_bf16 v22, v64, v64, v22
    v_dot2_f32_bf16 v17, v45, s73, v17
    v_dot2_f32_bf16 v19, v45, v45, v19
    v_dot2_f32_bf16 v21, v65, s73, v21
    v_dot2_f32_bf16 v23, v65, v65, v23
    v_dot2_f32_bf16 v16, v46, s73, v16
    v_dot2_f32_bf16 v18, v46, v46, v18
    v_dot2_f32_bf16 v20, v66, s73, v20
    v_dot2_f32_bf16 v22, v66, v66, v22
    v_dot2_f32_bf16 v17, v47, s73, v17
    v_dot2_f32_bf16 v19, v47, v47, v19
    v_dot2_f32_bf16 v21, v67, s73, v21
    v_dot2_f32_bf16 v23, v67, v67, v23
    v_dot2_f32_bf16 v16, v48, s73, v16
    v_dot2_f32_bf16 v18, v48, v48, v18
    v_dot2_f32_bf16 v20, v68, s73, v20
    v_dot2_f32_bf16 v22, v68, v68, v22
    v_dot2_f32_bf16 v17, v49, s73, v17
    v_dot2_f32_bf16 v19, v49, v49, v19
    v_dot2_f32_bf16 v21, v69, s73, v21
    v_dot2_f32_bf16 v23, v69, v69, v23
    v_dot2_f32_bf16 v16, v50, s73, v16
    v_dot2_f32_bf16 v18, v50, v50, v18
    v_dot2_f32_bf16 v20, v70, s73, v20
    v_dot2_f32_bf16 v22, v70, v70, v22
    v_dot2_f32_bf16 v17, v51, s73, v17
    v_dot2_f32_bf16 v19, v51, v51, v19
    v_dot2_f32_bf16 v21, v71, s73, v21
    v_dot2_f32_bf16 v23, v71, v71, v23
    s_nop 2
    v_add_f32 v16, v16, v17
    v_add_f32 v17, v18, v19
    v_add_f32 v20, v20, v21
    v_add_f32 v21, v22, v23
    v_add_f32_dpp v16, v16, v16 row_ror:8 row_mask:0xf bank_mask:0xf
    v_add_f32_dpp v17, v17, v17 row_ror:8 row_mask:0xf bank_mask:0xf
    v_add_f32_dpp v20, v20, v20 row_ror:8 row_mask:0xf bank_mask:0xf
    v_add_f32_dpp v21, v21, v21 row_ror:8 row_mask:0xf bank_mask:0xf
    v_add_f32_dpp v16, v16, v16 row_ror:4 row_mask:0xf bank_mask:0xf
    v_add_f32_dpp v17, v17, v17 row_ror:4 row_mask:0xf bank_mask:0xf
    v_add_f32_dpp v20, v20, v20 row_ror:4 row_mask:0xf bank_mask:0xf
    v_add_f32_dpp v21, v21, v21 row_ror:4 row_mask:0xf bank_mask:0xf
    v_add_f32_dpp v16, v16, v16 row_ror:2 row_mask:0xf bank_mask:0xf
    v_add_f32_dpp v17, v17, v17 row_ror:2 row_mask:0xf bank_mask:0xf
    v_add_f32_dpp v20, v20, v20 row_ror:2 row_mask:0xf bank_mask:0xf
    v_add_f32_dpp v21, v21, v21 row_ror:2 row_mask:0xf bank_mask:0xf
    v_add_f32_dpp v16, v16, v16 row_ror:1 row_mask:0xf bank_mask:0xf
    v_add_f32_dpp v17, v17, v17 row_ror:1 row_mask:0xf bank_mask:0xf
    v_add_f32_dpp v20, v20, v20 row_ror:1 row_mask:0xf bank_mask:0xf
    v_add_f32_dpp v21, v21, v21 row_ror:1 row_mask:0xf bank_mask:0xf
    s_nop 0
    v_mul_f32 v16, s75, v16
    v_mul_f32 v20, s75, v20
    v_mul_f32 v17, s75, v17
    v_mul_f32 v21, s75, v21
    v_fma_f32 v17, -v16, v16, v17
    v_fma_f32 v21, -v20, v20, v21
    v_max_f32 v17, 0, v17
    v_max_f32 v21, 0, v21
    v_cvt_pk_bf16_f32 v16, v16, v17
    v_cvt_pk_bf16_f32 v20, v20, v21
    v_and_b32 v17, s74, v16
    v_and_b32 v21, s74, v20
    v_lshlrev_b32 v16, 16, v16
    v_lshlrev_b32 v20, 16, v20
    v_add_f32 v17, 0x3727c5ac, v17
    v_add_f32 v21, 0x3727c5ac, v21
    v_cvt_pk_bf16_f32 v17, v17, v17
    v_cvt_pk_bf16_f32 v21, v21, v21
    v_and_b32 v17, s74, v17
    v_and_b32 v21, s74, v21
    v_sqrt_f32 v17, v17
    v_sqrt_f32 v21, v21
    s_nop 0
    v_cvt_pk_bf16_f32 v17, v17, v17
    v_cvt_pk_bf16_f32 v21, v21, v21
    v_and_b32 v17, s74, v17
    v_and_b32 v21, s74, v21
    v_rcp_f32 v17, v17
    v_rcp_f32 v21, v21
    s_nop 0
    v_mul_f32 v16, v16, v17
    v_mul_f32 v20, v20, v21
    v_sub_f32 v16, 0, v16
    v_sub_f32 v20, 0, v20
    v_lshlrev_b32 v30, 2, v8
    v_add_u32 v31, 16, v30
    v_cmp_eq_u32 vcc, 0, v3
    s_and_saveexec_b64 s[76:77], vcc
    s_mov_b32 s78, 6291456
    s_mov_b32 s79, 6299648
    buffer_store_dword v16, v30, s[8:11], s78 offen sc0 sc1
    buffer_store_dword v17, v30, s[8:11], s79 offen sc0 sc1
    buffer_store_dword v20, v31, s[8:11], s78 offen sc0 sc1
    buffer_store_dword v21, v31, s[8:11], s79 offen sc0 sc1
    s_mov_b64 exec, s[76:77]
    s_waitcnt vmcnt(0)
    v_readfirstlane_b32 s12, v251
    s_nop 3
    s_cmp_lg_u32 s12, 0
    s_cbranch_scc1 L_f_nok_21
    s_mov_b32 s13, 40000
L_f_nspin_22:
    v_mov_b32 v253, 0
    buffer_load_dword v251, v253, s[28:31], 0 offen sc0 sc1
    s_waitcnt vmcnt(0)
    v_readfirstlane_b32 s12, v251
    s_nop 3
    s_cmp_lg_u32 s12, 0
    s_cbranch_scc1 L_f_nok_21
    s_sub_u32 s13, s13, 1
    s_cmp_eq_u32 s13, 0
    s_cbranch_scc1 L_bail
    s_branch L_f_nspin_22
L_f_nok_21:
    s_waitcnt vmcnt(0)
    s_barrier
    s_cmp_lg_u32 s3, 0
    s_cbranch_scc1 L_f_flag_23
    s_lshl_b32 s97, s2, 4
    s_add_u32 s97, s97, 24281088
    s_mov_b64 exec, 0xff
    v_mov_b32 v252, s12
    v_lshlrev_b32 v253, 12, v0
    buffer_store_dword v252, v253, s[8:11], s97 offen sc0 sc1
    s_mov_b64 exec, -1
L_f_flag_23:
    s_add_u32 m0, s66, 61440
    s_add_u32 s73, s71, 0
    buffer_load_dwordx4 v11, s[20:23], s73 offen nt lds
    s_add_u32 m0, s66, 65536
    s_add_u32 s73, s71, 40960
    buffer_load_dwordx4 v11, s[20:23], s73 offen nt lds
    s_add_u32 m0, s66, 69632
    s_add_u32 s73, s71, 81920
    buffer_load_dwordx4 v11, s[20:23], s73 offen nt lds
    s_add_u32 m0, s66, 73728
    s_add_u32 s73, s71, 122880
    buffer_load_dwordx4 v11, s[20:23], s73 offen nt lds
    s_add_u32 m0, s66, 77824
    s_add_u32 s73, s71, 163840
    buffer_load_dwordx4 v11, s[20:23], s73 offen nt lds
    s_add_u32 m0, s66, 81920
    s_add_u32 s73, s71, 204800
    buffer_load_dwordx4 v11, s[20:23], s73 offen nt lds
    s_waitcnt vmcnt(0)
    s_barrier
    s_branch L_f_w2pack_20
L_f_wpath_19:
    v_mul_u32_u24 v7, 3072, v4
    v_add_u32 v7, v7, v5
    s_sub_u32 s61, s60, 64
    s_mul_i32 s61, s61, 3
    s_add_u32 s62, s61, 0
    s_and_b32 s63, s62, 3
    s_lshr_b32 s62, s62, 2
    s_mul_i32 s64, s63, 491520
    s_lshl_b32 s65, s62, 7
    s_add_u32 s64, s64, s65
    s_mul_i32 s65, s3, 24576
    s_add_u32 s64, s64, s65
    s_add_u32 m0, s66, 0
    s_add_u32 s67, s64, 0
    buffer_load_dwordx4 v7, s[16:19], s67 offen nt lds
    s_add_u32 m0, s66, 4096
    s_add_u32 s67, s64, 98304
    buffer_load_dwordx4 v7, s[16:19], s67 offen nt lds
    s_add_u32 m0, s66, 8192
    s_add_u32 s67, s64, 196608
    buffer_load_dwordx4 v7, s[16:19], s67 offen nt lds
    s_add_u32 m0, s66, 12288
    s_add_u32 s67, s64, 294912
    buffer_load_dwordx4 v7, s[16:19], s67 offen nt lds
    s_add_u32 m0, s66, 16384
    s_add_u32 s67, s64, 393216
    buffer_load_dwordx4 v7, s[16:19], s67 offen nt lds
    s_add_u32 s62, s61, 1
    s_and_b32 s63, s62, 3
    s_lshr_b32 s62, s62, 2
    s_mul_i32 s64, s63, 491520
    s_lshl_b32 s65, s62, 7
    s_add_u32 s64, s64, s65
    s_mul_i32 s65, s3, 24576
    s_add_u32 s64, s64, s65
    s_add_u32 m0, s66, 20480
    s_add_u32 s67, s64, 0
    buffer_load_dwordx4 v7, s[16:19], s67 offen nt lds
    s_add_u32 m0, s66, 24576
    s_add_u32 s67, s64, 98304
    buffer_load_dwordx4 v7, s[16:19], s67 offen nt lds
    s_add_u32 m0, s66, 28672
    s_add_u32 s67, s64, 196608
    buffer_load_dwordx4 v7, s[16:19], s67 offen nt lds
    s_add_u32 m0, s66, 32768
    s_add_u32 s67, s64, 294912
    buffer_load_dwordx4 v7, s[16:19], s67 offen nt lds
    s_add_u32 m0, s66, 36864
    s_add_u32 s67, s64, 393216
    buffer_load_dwordx4 v7, s[16:19], s67 offen nt lds
    s_add_u32 s62, s61, 2
    s_and_b32 s63, s62, 3
    s_lshr_b32 s62, s62, 2
    s_mul_i32 s64, s63, 491520
    s_lshl_b32 s65, s62, 7
    s_add_u32 s64, s64, s65
    s_mul_i32 s65, s3, 24576
    s_add_u32 s64, s64, s65
    s_add_u32 m0, s66, 40960
    s_add_u32 s67, s64, 0
    buffer_load_dwordx4 v7, s[16:19], s67 offen nt lds
    s_add_u32 m0, s66, 45056
    s_add_u32 s67, s64, 98304
    buffer_load_dwordx4 v7, s[16:19], s67 offen nt lds
    s_add_u32 m0, s66, 49152
    s_add_u32 s67, s64, 196608
    buffer_load_dwordx4 v7, s[16:19], s67 offen nt lds
    s_add_u32 m0, s66, 53248
    s_add_u32 s67, s64, 294912
    buffer_load_dwordx4 v7, s[16:19], s67 offen nt lds
    s_add_u32 m0, s66, 57344
    s_add_u32 s67, s64, 393216
    buffer_load_dwordx4 v7, s[16:19], s67 offen nt lds
    v_lshrrev_b32 v12, 2, v3
    v_lshl_add_u32 v12, v2, 3, v12
    v_lshlrev_b32 v12, 7, v12
    v_lshrrev_b32 v13, 3, v3
    v_and_b32 v14, 1, v2
    v_lshl_or_b32 v13, v14, 1, v13
    v_xor_b32 v13, s3, v13
    v_lshl_add_u32 v12, v13, 5, v12
    v_and_b32 v14, 3, v3
    v_lshl_add_u32 v12, v14, 3, v12
    v_mov_b32 v16, 0x3f803f80
    v_mov_b32 v17, 0x3f803f80
    v_mov_b32 v18, 0x3f803f80
    v_mov_b32 v19, 0x3f803f80
    v_lshlrev_b32 v15, 4, v2
    s_waitcnt vmcnt(10)
    s_barrier
    s_add_u32 s62, s61, 0
    s_and_b32 s63, s62, 3
    s_lshr_b32 s62, s62, 2
    s_lshl_b32 s73, s62, 2
    s_add_u32 s73, s73, s3
    s_mul_i32 s74, s73, 43691
    s_lshr_b32 s74, s74, 19
    s_mul_i32 s75, s74, 12
    s_sub_u32 s75, s73, s75
    s_mul_i32 s76, s75, 43691
    s_lshr_b32 s76, s76, 17
    s_mul_i32 s77, s76, 3
    s_sub_u32 s77, s75, s77
    s_add_u32 s78, s77, 2
    s_cmp_ge_u32 s78, 3
    s_cselect_b32 s79, 3, 0
    s_sub_u32 s78, s78, s79
    s_bitcmp1_b32 s76, 0
    s_cselect_b32 s77, s78, s77
    s_lshl_b32 s74, s74, 2
    s_add_u32 s74, s74, s76
    s_mul_i32 s74, s74, 20
    s_mul_i32 s75, s63, 5
    s_add_u32 s74, s74, s75
    s_mul_i32 s74, s74, 3
    s_add_u32 s74, s74, s77
    s_lshl_b32 s74, s74, 10
    s_add_u32 s74, s74, 10485760
    ds_read_b64_tr_b16 v[120:121], v12 offset:0
    ds_read_b64_tr_b16 v[122:123], v12 offset:512
    ds_read_b64_tr_b16 v[124:125], v12 offset:4096
    ds_read_b64_tr_b16 v[126:127], v12 offset:4608
    ds_read_b64_tr_b16 v[128:129], v12 offset:8192
    ds_read_b64_tr_b16 v[130:131], v12 offset:8704
    ds_read_b64_tr_b16 v[132:133], v12 offset:12288
    ds_read_b64_tr_b16 v[134:135], v12 offset:12800
    ds_read_b64_tr_b16 v[136:137], v12 offset:16384
    ds_read_b64_tr_b16 v[138:139], v12 offset:16896
    s_waitcnt lgkmcnt(8)
    v_mfma_f32_16x16x32_bf16 v[20:23], v[120:123], v[16:19], 0
    buffer_store_dwordx4 v[120:123], v1, s[8:11], s74 offen sc0 sc1
    s_add_u32 s74, s74, 3072
    s_waitcnt lgkmcnt(6)
    v_mfma_f32_16x16x32_bf16 v[20:23], v[124:127], v[16:19], v[20:23]
    buffer_store_dwordx4 v[124:127], v1, s[8:11], s74 offen sc0 sc1
    s_add_u32 s74, s74, 3072
    s_waitcnt lgkmcnt(4)
    v_mfma_f32_16x16x32_bf16 v[20:23], v[128:131], v[16:19], v[20:23]
    buffer_store_dwordx4 v[128:131], v1, s[8:11], s74 offen sc0 sc1
    s_add_u32 s74, s74, 3072
    s_waitcnt lgkmcnt(2)
    v_mfma_f32_16x16x32_bf16 v[20:23], v[132:135], v[16:19], v[20:23]
    buffer_store_dwordx4 v[132:135], v1, s[8:11], s74 offen sc0 sc1
    s_add_u32 s74, s74, 3072
    s_waitcnt lgkmcnt(0)
    v_mfma_f32_16x16x32_bf16 v[20:23], v[136:139], v[16:19], v[20:23]
    buffer_store_dwordx4 v[136:139], v1, s[8:11], s74 offen sc0 sc1
    s_add_u32 s74, s74, 3072
    s_lshl_b32 s75, s73, 8
    s_lshl_b32 s76, s63, 6
    s_add_u32 s75, s75, s76
    s_add_u32 s75, s75, 14680064
    s_nop 4
    v_cmp_eq_u32 vcc, 0, v3
    s_and_saveexec_b64 s[76:77], vcc
    buffer_store_dwordx4 v[20:23], v15, s[8:11], s75 offen sc0 sc1
    s_mov_b64 exec, s[76:77]
    s_waitcnt vmcnt(11)
    s_barrier
    s_add_u32 s62, s61, 1
    s_and_b32 s63, s62, 3
    s_lshr_b32 s62, s62, 2
    s_lshl_b32 s73, s62, 2
    s_add_u32 s73, s73, s3
    s_mul_i32 s74, s73, 43691
    s_lshr_b32 s74, s74, 19
    s_mul_i32 s75, s74, 12
    s_sub_u32 s75, s73, s75
    s_mul_i32 s76, s75, 43691
    s_lshr_b32 s76, s76, 17
    s_mul_i32 s77, s76, 3
    s_sub_u32 s77, s75, s77
    s_add_u32 s78, s77, 2
    s_cmp_ge_u32 s78, 3
    s_cselect_b32 s79, 3, 0
    s_sub_u32 s78, s78, s79
    s_bitcmp1_b32 s76, 0
    s_cselect_b32 s77, s78, s77
    s_lshl_b32 s74, s74, 2
    s_add_u32 s74, s74, s76
    s_mul_i32 s74, s74, 20
    s_mul_i32 s75, s63, 5
    s_add_u32 s74, s74, s75
    s_mul_i32 s74, s74, 3
    s_add_u32 s74, s74, s77
    s_lshl_b32 s74, s74, 10
    s_add_u32 s74, s74, 10485760
    ds_read_b64_tr_b16 v[144:145], v12 offset:20480
    ds_read_b64_tr_b16 v[146:147], v12 offset:20992
    ds_read_b64_tr_b16 v[148:149], v12 offset:24576
    ds_read_b64_tr_b16 v[150:151], v12 offset:25088
    ds_read_b64_tr_b16 v[152:153], v12 offset:28672
    ds_read_b64_tr_b16 v[154:155], v12 offset:29184
    ds_read_b64_tr_b16 v[156:157], v12 offset:32768
    ds_read_b64_tr_b16 v[158:159], v12 offset:33280
    ds_read_b64_tr_b16 v[160:161], v12 offset:36864
    ds_read_b64_tr_b16 v[162:163], v12 offset:37376
    s_waitcnt lgkmcnt(8)
    v_mfma_f32_16x16x32_bf16 v[24:27], v[144:147], v[16:19], 0
    buffer_store_dwordx4 v[144:147], v1, s[8:11], s74 offen sc0 sc1
    s_add_u32 s74, s74, 3072
    s_waitcnt lgkmcnt(6)
    v_mfma_f32_16x16x32_bf16 v[24:27], v[148:151], v[16:19], v[24:27]
    buffer_store_dwordx4 v[148:151], v1, s[8:11], s74 offen sc0 sc1
    s_add_u32 s74, s74, 3072
    s_waitcnt lgkmcnt(4)
    v_mfma_f32_16x16x32_bf16 v[24:27], v[152:155], v[16:19], v[24:27]
    buffer_store_dwordx4 v[152:155], v1, s[8:11], s74 offen sc0 sc1
    s_add_u32 s74, s74, 3072
    s_waitcnt lgkmcnt(2)
    v_mfma_f32_16x16x32_bf16 v[24:27], v[156:159], v[16:19], v[24:27]
    buffer_store_dwordx4 v[156:159], v1, s[8:11], s74 offen sc0 sc1
    s_add_u32 s74, s74, 3072
    s_waitcnt lgkmcnt(0)
    v_mfma_f32_16x16x32_bf16 v[24:27], v[160:163], v[16:19], v[24:27]
    buffer_store_dwordx4 v[160:163], v1, s[8:11], s74 offen sc0 sc1
    s_add_u32 s74, s74, 3072
    s_lshl_b32 s75, s73, 8
    s_lshl_b32 s76, s63, 6
    s_add_u32 s75, s75, s76
    s_add_u32 s75, s75, 14680064
    s_nop 4
    v_cmp_eq_u32 vcc, 0, v3
    s_and_saveexec_b64 s[76:77], vcc
    buffer_store_dwordx4 v[24:27], v15, s[8:11], s75 offen sc0 sc1
    s_mov_b64 exec, s[76:77]
    buffer_load_dword v251, v253, s[28:31], 0 offen sc0 sc1
    s_waitcnt vmcnt(13)
    s_barrier
    s_add_u32 s62, s61, 2
    s_and_b32 s63, s62, 3
    s_lshr_b32 s62, s62, 2
    s_lshl_b32 s73, s62, 2
    s_add_u32 s73, s73, s3
    s_mul_i32 s74, s73, 43691
    s_lshr_b32 s74, s74, 19
    s_mul_i32 s75, s74, 12
    s_sub_u32 s75, s73, s75
    s_mul_i32 s76, s75, 43691
    s_lshr_b32 s76, s76, 17
    s_mul_i32 s77, s76, 3
    s_sub_u32 s77, s75, s77
    s_add_u32 s78, s77, 2
    s_cmp_ge_u32 s78, 3
    s_cselect_b32 s79, 3, 0
    s_sub_u32 s78, s78, s79
    s_bitcmp1_b32 s76, 0
    s_cselect_b32 s77, s78, s77
    s_lshl_b32 s74, s74, 2
    s_add_u32 s74, s74, s76
    s_mul_i32 s74, s74, 20
    s_mul_i32 s75, s63, 5
    s_add_u32 s74, s74, s75
    s_mul_i32 s74, s74, 3
    s_add_u32 s74, s74, s77
    s_lshl_b32 s74, s74, 10
    s_add_u32 s74, s74, 10485760
    ds_read_b64_tr_b16 v[168:169], v12 offset:40960
    ds_read_b64_tr_b16 v[170:171], v12 offset:41472
    ds_read_b64_tr_b16 v[172:173], v12 offset:45056
    ds_read_b64_tr_b16 v[174:175], v12 offset:45568
    ds_read_b64_tr_b16 v[176:177], v12 offset:49152
    ds_read_b64_tr_b16 v[178:179], v12 offset:49664
    ds_read_b64_tr_b16 v[180:181], v12 offset:53248
    ds_read_b64_tr_b16 v[182:183], v12 offset:53760
    ds_read_b64_tr_b16 v[184:185], v12 offset:57344
    ds_read_b64_tr_b16 v[186:187], v12 offset:57856
    s_waitcnt lgkmcnt(8)
    v_mfma_f32_16x16x32_bf16 v[28:31], v[168:171], v[16:19], 0
    buffer_store_dwordx4 v[168:171], v1, s[8:11], s74 offen sc0 sc1
    s_add_u32 s74, s74, 3072
    s_waitcnt lgkmcnt(6)
    v_mfma_f32_16x16x32_bf16 v[28:31], v[172:175], v[16:19], v[28:31]
    buffer_store_dwordx4 v[172:175], v1, s[8:11], s74 offen sc0 sc1
    s_add_u32 s74, s74, 3072
    s_waitcnt lgkmcnt(4)
    v_mfma_f32_16x16x32_bf16 v[28:31], v[176:179], v[16:19], v[28:31]
    buffer_store_dwordx4 v[176:179], v1, s[8:11], s74 offen sc0 sc1
    s_add_u32 s74, s74, 3072
    s_waitcnt lgkmcnt(2)
    v_mfma_f32_16x16x32_bf16 v[28:31], v[180:183], v[16:19], v[28:31]
    buffer_store_dwordx4 v[180:183], v1, s[8:11], s74 offen sc0 sc1
    s_add_u32 s74, s74, 3072
    s_waitcnt lgkmcnt(0)
    v_mfma_f32_16x16x32_bf16 v[28:31], v[184:187], v[16:19], v[28:31]
    buffer_store_dwordx4 v[184:187], v1, s[8:11], s74 offen sc0 sc1
    s_add_u32 s74, s74, 3072
    s_lshl_b32 s75, s73, 8
    s_lshl_b32 s76, s63, 6
    s_add_u32 s75, s75, s76
    s_add_u32 s75, s75, 14680064
    s_nop 4
    v_cmp_eq_u32 vcc, 0, v3
    s_and_saveexec_b64 s[76:77], vcc
    buffer_store_dwordx4 v[28:31], v15, s[8:11], s75 offen sc0 sc1
    s_mov_b64 exec, s[76:77]
    s_add_u32 m0, s66, 61440
    s_add_u32 s73, s71, 0
    buffer_load_dwordx4 v11, s[20:23], s73 offen nt lds
    s_add_u32 m0, s66, 65536
    s_add_u32 s73, s71, 40960
    buffer_load_dwordx4 v11, s[20:23], s73 offen nt lds
    s_add_u32 m0, s66, 69632
    s_add_u32 s73, s71, 81920
    buffer_load_dwordx4 v11, s[20:23], s73 offen nt lds
    s_add_u32 m0, s66, 73728
    s_add_u32 s73, s71, 122880
    buffer_load_dwordx4 v11, s[20:23], s73 offen nt lds
    s_add_u32 m0, s66, 77824
    s_add_u32 s73, s71, 163840
    buffer_load_dwordx4 v11, s[20:23], s73 offen nt lds
    s_add_u32 m0, s66, 81920
    s_add_u32 s73, s71, 204800
    buffer_load_dwordx4 v11, s[20:23], s73 offen nt lds
    s_waitcnt vmcnt(12)
    v_readfirstlane_b32 s12, v251
    s_nop 3
    s_cmp_lg_u32 s12, 0
    s_cbranch_scc1 L_f_nok_24
    s_mov_b32 s13, 40000
L_f_nspin_25:
    v_mov_b32 v253, 0
    buffer_load_dword v251, v253, s[28:31], 0 offen sc0 sc1
    s_waitcnt vmcnt(0)
    v_readfirstlane_b32 s12, v251
    s_nop 3
    s_cmp_lg_u32 s12, 0
    s_cbranch_scc1 L_f_nok_24
    s_sub_u32 s13, s13, 1
    s_cmp_eq_u32 s13, 0
    s_cbranch_scc1 L_bail
    s_branch L_f_nspin_25
L_f_nok_24:
    s_waitcnt vmcnt(6)
    s_barrier
    s_sub_u32 s75, s60, 64
    s_lshl_b32 s75, s75, 6
    s_add_u32 s75, s75, 24215552
    s_cmp_lg_u32 s3, 0
    s_cbranch_scc1 L_f_flag_26
    s_mov_b64 exec, 1
    v_mov_b32 v252, s12
    v_mov_b32 v253, 0
    buffer_store_dword v252, v253, s[8:11], s75 offen sc0 sc1
    s_mov_b64 exec, -1
L_f_flag_26:
    s_waitcnt vmcnt(0)
    s_barrier
L_f_w2pack_20:
    s_cmp_ge_u32 s45, 80
    s_cbranch_scc1 L_f_nopack2_27
    s_lshl_b32 s73, s69, 2
    s_add_u32 s73, s73, s3
    s_mul_i32 s74, s73, 52429
    s_lshr_b32 s74, s74, 18
    s_mul_i32 s75, s74, 5
    s_sub_u32 s75, s73, s75
    s_mul_i32 s74, s74, 48
    s_mul_i32 s76, s70, 6
    s_add_u32 s74, s74, s76
    s_mul_i32 s74, s74, 5
    s_add_u32 s74, s74, s75
    s_lshl_b32 s74, s74, 10
    s_add_u32 s74, s74, 12582912
    v_lshrrev_b32 v12, 2, v3
    v_lshl_add_u32 v12, v2, 2, v12
    v_lshlrev_b32 v12, 7, v12
    v_lshrrev_b32 v13, 3, v3
    v_lshrrev_b32 v14, 1, v2
    v_lshl_or_b32 v13, v14, 1, v13
    v_xor_b32 v13, s3, v13
    v_lshl_add_u32 v12, v13, 5, v12
    v_and_b32 v14, 3, v3
    v_lshl_add_u32 v12, v14, 3, v12
    v_add_u32 v12, 61440, v12
    ds_read_b64_tr_b16 v[120:121], v12 offset:0
    ds_read_b64_tr_b16 v[122:123], v12 offset:2048
    ds_read_b64_tr_b16 v[124:125], v12 offset:4096
    ds_read_b64_tr_b16 v[126:127], v12 offset:6144
    ds_read_b64_tr_b16 v[128:129], v12 offset:8192
    ds_read_b64_tr_b16 v[130:131], v12 offset:10240
    ds_read_b64_tr_b16 v[132:133], v12 offset:12288
    ds_read_b64_tr_b16 v[134:135], v12 offset:14336
    ds_read_b64_tr_b16 v[136:137], v12 offset:16384
    ds_read_b64_tr_b16 v[138:139], v12 offset:18432
    ds_read_b64_tr_b16 v[140:141], v12 offset:20480
    ds_read_b64_tr_b16 v[142:143], v12 offset:22528
    s_waitcnt lgkmcnt(10)
    buffer_store_dwordx4 v[120:123], v1, s[8:11], s74 offen sc0 sc1
    s_add_u32 s74, s74, 5120
    s_waitcnt lgkmcnt(8)
    buffer_store_dwordx4 v[124:127], v1, s[8:11], s74 offen sc0 sc1
    s_add_u32 s74, s74, 5120
    s_waitcnt lgkmcnt(6)
    buffer_store_dwordx4 v[128:131], v1, s[8:11], s74 offen sc0 sc1
    s_add_u32 s74, s74, 5120
    s_waitcnt lgkmcnt(4)
    buffer_store_dwordx4 v[132:135], v1, s[8:11], s74 offen sc0 sc1
    s_add_u32 s74, s74, 5120
    s_waitcnt lgkmcnt(2)
    buffer_store_dwordx4 v[136:139], v1, s[8:11], s74 offen sc0 sc1
    s_add_u32 s74, s74, 5120
    s_waitcnt lgkmcnt(0)
    buffer_store_dwordx4 v[140:143], v1, s[8:11], s74 offen sc0 sc1
    s_add_u32 s74, s74, 5120
    s_waitcnt vmcnt(0)
    s_barrier
    s_lshl_b32 s75, s45, 6
    s_add_u32 s75, s75, 24223744
    s_cmp_lg_u32 s3, 0
    s_cbranch_scc1 L_f_flag_28
    s_mov_b64 exec, 1
    v_mov_b32 v252, s12
    v_mov_b32 v253, 0
    buffer_store_dword v252, v253, s[8:11], s75 offen sc0 sc1
    s_mov_b64 exec, -1
L_f_flag_28:
L_f_nopack2_27:
    s_mov_b32 s16, s48
    s_and_b32 s17, s49, 0xffff
    s_mov_b32 s18, 0xc00
    s_mov_b32 s19, 0x00020000
    s_mov_b32 s20, s54
    s_and_b32 s21, s55, 0xffff
    s_mov_b32 s22, 0x280000
    s_mov_b32 s23, 0x00020000
    s_mov_b32 s24, s52
    s_and_b32 s25, s53, 0xffff
    s_mov_b32 s26, 0x500
    s_mov_b32 s27, 0x00020000
    s_and_b32 s40, s3, 1
    s_mul_i32 s70, s5, 12
    s_mul_i32 s71, s3, 3
    s_add_u32 s70, s70, s71
    s_add_u32 s71, s70, s40
    s_lshl_b32 s41, s71, 5
    s_add_u32 s58, s41, 32
    s_mul_i32 s72, s40, 3
    s_add_u32 s73, s70, 2
    s_sub_u32 s73, s73, s72
    s_add_u32 s73, s73, s40
    s_lshl_b32 s59, s73, 5
    s_mul_i32 s74, s5, 6
    s_mul_i32 s75, s3, 3
    s_add_u32 s76, s75, s40
    s_lshr_b32 s76, s76, 1
    s_add_u32 s76, s76, s74
    s_mul_i32 s77, s40, 3
    s_add_u32 s75, s75, 2
    s_sub_u32 s75, s75, s77
    s_lshr_b32 s75, s75, 1
    s_add_u32 s75, s75, s74
    s_xor_b32 s70, s40, 0
    s_lshl_b32 s71, s4, 1
    s_add_u32 s70, s70, s71
    s_mul_i32 s70, s70, 48
    s_add_u32 s52, s70, s76
    s_lshl_b32 s52, s52, 10
    s_add_u32 s52, s52, 16777216
    s_add_u32 s53, s70, s75
    s_lshl_b32 s53, s53, 10
    s_add_u32 s53, s53, 16777216
    s_xor_b32 s70, s40, 1
    s_lshl_b32 s71, s4, 1
    s_add_u32 s70, s70, s71
    s_mul_i32 s70, s70, 48
    s_add_u32 s54, s70, s76
    s_lshl_b32 s54, s54, 10
    s_add_u32 s54, s54, 16777216
    s_add_u32 s55, s70, s75
    s_lshl_b32 s55, s55, 10
    s_add_u32 s55, s55, 16777216
    s_mul_i32 s57, s5, 245760
    s_mul_i32 s70, s3, 61440
    s_add_u32 s57, s57, s70
    s_add_u32 s57, s57, 12582912
    s_add_u32 s48, s57, 46080
    s_mul_i32 s51, s3, 15360
    s_add_u32 s51, s51, 40960
    v_and_b32 v234, 3, v3
    v_cmp_eq_u32 s[32:33], 1, v234
    v_cmp_eq_u32 s[34:35], 2, v234
    v_cmp_eq_u32 s[36:37], 3, v234
    v_lshrrev_b32 v234, 2, v3
    v_cmp_eq_u32 s[38:39], v234, v2
    s_lshl_b32 s70, s3, 7
    s_add_u32 s70, s70, 158720
    v_lshl_add_u32 v234, v3, 3, s70
    s_lshl_b32 s70, s40, 7
    s_add_u32 s70, s70, 158720
    v_lshl_add_u32 v235, v3, 3, s70
    s_lshr_b32 s70, s3, 1
    s_lshl_b32 s70, s70, 4
    s_mul_i32 s71, s5, 80
    s_add_u32 s70, s70, s71
    s_lshl_b32 s42, s70, 1
    s_lshl_b32 s71, s70, 6
    s_add_u32 s71, s71, 117760
    v_lshrrev_b32 v248, 2, v3
    v_lshl_add_u32 v248, v2, 2, v248
    v_lshlrev_b32 v248, 6, v248
    v_lshrrev_b32 v249, 1, v2
    v_xor_b32 v249, s40, v249
    v_lshl_add_u32 v248, v249, 5, v248
    v_and_b32 v249, 3, v3
    v_lshl_add_u32 v248, v249, 3, v248
    v_add_u32 v248, s71, v248
    v_mul_u32_u24 v249, 1280, v3
    v_lshl_add_u32 v249, v2, 3, v249
    s_lshl_b32 s71, s3, 10
    s_add_u32 s71, s71, 0
    v_add_u32 v250, s71, v1
    s_lshl_b32 s46, s4, 1
    s_add_u32 s46, s46, s40
    s_mul_i32 s46, s46, 20480
    s_add_u32 s46, s46, s42
    s_cmp_ge_u32 s3, 2
    s_cselect_b32 s43, 0x7ffff000, s46
    s_sub_u32 s62, s2, 160
    s_cmp_ge_u32 s62, 24
    s_cbranch_scc1 L_f_nocs_29
    s_lshl_b32 s63, s3, 3
    v_add_u32 v14, s63, v0
    v_lshlrev_b32 v14, 6, v14
    s_mov_b32 s91, 24215552
    s_bfm_b64 exec, 8, 0
    buffer_load_dword v15, v14, s[8:11], s91 offen sc0 sc1
    s_mov_b64 exec, -1
    s_waitcnt vmcnt(0)
    s_bfm_b64 exec, 8, 0
    v_cmp_ne_u32 vcc, s12, v15
    s_mov_b64 exec, -1
    s_cbranch_vccz L_f_pok_30
    s_mov_b32 s13, 40000
L_f_pspin_31:
    s_bfm_b64 exec, 8, 0
    buffer_load_dword v15, v14, s[8:11], s91 offen sc0 sc1
    s_waitcnt vmcnt(0)
    v_cmp_ne_u32 vcc, s12, v15
    s_mov_b64 exec, -1
    s_cbranch_vccz L_f_pok_30
    s_sub_u32 s13, s13, 1
    s_cmp_eq_u32 s13, 0
    s_cbranch_scc1 L_bail
    s_branch L_f_pspin_31
L_f_pok_30:
    s_barrier
    s_cmp_lg_u32 s3, 0
    s_cbranch_scc1 L_f_nocs_29
    v_lshlrev_b32 v14, 8, v2
    v_lshl_add_u32 v14, v3, 2, v14
    s_lshl_b32 s63, s62, 10
    s_add_u32 s63, s63, 14680064
    buffer_load_dword v20, v14, s[8:11], s63 offen offset:0 sc1
    buffer_load_dword v21, v14, s[8:11], s63 offen offset:64 sc1
    buffer_load_dword v22, v14, s[8:11], s63 offen offset:128 sc1
    buffer_load_dword v23, v14, s[8:11], s63 offen offset:192 sc1
    v_lshlrev_b32 v15, 2, v0
    s_lshl_b32 s63, s62, 8
    s_add_u32 s63, s63, 14745600
    s_waitcnt vmcnt(0)
    v_add_f32 v20, v20, v21
    v_add_f32 v22, v22, v23
    v_add_f32 v20, v20, v22
    buffer_store_dword v20, v15, s[8:11], s63 offen sc0 sc1
    s_waitcnt vmcnt(0)
    s_lshl_b32 s63, s62, 6
    s_add_u32 s63, s63, 24313856
    s_cmp_lg_u32 s3, 0
    s_cbranch_scc1 L_f_flag_32
    s_mov_b64 exec, 1
    v_mov_b32 v252, s12
    v_mov_b32 v253, 0
    buffer_store_dword v252, v253, s[8:11], s63 offen sc0 sc1
    s_mov_b64 exec, -1
L_f_flag_32:
L_f_nocs_29:
    s_lshl_b32 s62, s5, 2
    v_add_u32 v14, s62, v0
    v_lshlrev_b32 v14, 6, v14
    s_mov_b32 s91, 24215552
    s_bfm_b64 exec, 4, 0
    buffer_load_dword v15, v14, s[8:11], s91 offen sc0 sc1
    s_mov_b64 exec, -1
    v_lshrrev_b32 v210, 2, v0
    v_and_b32 v211, 3, v0
    v_lshrrev_b32 v212, 5, v0
    v_lshlrev_b32 v212, 1, v212
    v_xor_b32 v211, v211, v212
    v_lshlrev_b32 v211, 4, v211
    v_lshl_add_u32 v210, v210, 6, v211
    s_lshl_b32 s84, s5, 2
    s_add_u32 s84, s84, s3
    s_mul_i32 s84, s84, 61440
    s_add_u32 s84, s84, 10455040
    s_lshr_b32 s85, s3, 1
    s_mul_i32 s85, s85, 30720
    v_add_u32 v213, 30720, v1
    v_subrev_u32 v214, s85, v213
    v_add_u32 v213, s85, v213
    s_waitcnt vmcnt(0)
    s_bfm_b64 exec, 4, 0
    v_cmp_ne_u32 vcc, s12, v15
    s_mov_b64 exec, -1
    s_cbranch_vccz L_f_pok_33
    s_mov_b32 s13, 40000
L_f_pspin_34:
    s_bfm_b64 exec, 4, 0
    buffer_load_dword v15, v14, s[8:11], s91 offen sc0 sc1
    s_waitcnt vmcnt(0)
    v_cmp_ne_u32 vcc, s12, v15
    s_mov_b64 exec, -1
    s_cbranch_vccz L_f_pok_33
    s_sub_u32 s13, s13, 1
    s_cmp_eq_u32 s13, 0
    s_cbranch_scc1 L_bail
    s_branch L_f_pspin_34
L_f_pok_33:
    buffer_load_dwordx4 a[0:3], v213, s[8:11], s84 offen offset:0 sc1
    buffer_load_dwordx4 a[4:7], v213, s[8:11], s84 offen offset:1024 sc1
    buffer_load_dwordx4 a[8:11], v213, s[8:11], s84 offen offset:2048 sc1
    s_add_u32 s84, s84, 3072
    buffer_load_dwordx4 a[12:15], v213, s[8:11], s84 offen offset:0 sc1
    buffer_load_dwordx4 a[16:19], v213, s[8:11], s84 offen offset:1024 sc1
    buffer_load_dwordx4 a[20:23], v213, s[8:11], s84 offen offset:2048 sc1
    s_add_u32 s84, s84, 3072
    buffer_load_dwordx4 a[24:27], v213, s[8:11], s84 offen offset:0 sc1
    buffer_load_dwordx4 a[28:31], v213, s[8:11], s84 offen offset:1024 sc1
    buffer_load_dwordx4 a[32:35], v213, s[8:11], s84 offen offset:2048 sc1
    s_add_u32 s84, s84, 3072
    buffer_load_dwordx4 a[36:39], v213, s[8:11], s84 offen offset:0 sc1
    buffer_load_dwordx4 a[40:43], v213, s[8:11], s84 offen offset:1024 sc1
    buffer_load_dwordx4 a[44:47], v213, s[8:11], s84 offen offset:2048 sc1
    s_add_u32 s84, s84, 3072
    buffer_load_dwordx4 a[48:51], v213, s[8:11], s84 offen offset:0 sc1
    buffer_load_dwordx4 a[52:55], v213, s[8:11], s84 offen offset:1024 sc1
    buffer_load_dwordx4 a[56:59], v213, s[8:11], s84 offen offset:2048 sc1
    s_add_u32 s84, s84, 3072
    buffer_load_dwordx4 a[60:63], v213, s[8:11], s84 offen offset:0 sc1
    buffer_load_dwordx4 a[64:67], v213, s[8:11], s84 offen offset:1024 sc1
    buffer_load_dwordx4 a[68:71], v213, s[8:11], s84 offen offset:2048 sc1
    s_add_u32 s84, s84, 3072
    buffer_load_dwordx4 a[72:75], v213, s[8:11], s84 offen offset:0 sc1
    buffer_load_dwordx4 a[76:79], v213, s[8:11], s84 offen offset:1024 sc1
    buffer_load_dwordx4 a[80:83], v213, s[8:11], s84 offen offset:2048 sc1
    s_add_u32 s84, s84, 3072
    buffer_load_dwordx4 a[84:87], v213, s[8:11], s84 offen offset:0 sc1
    buffer_load_dwordx4 a[88:91], v213, s[8:11], s84 offen offset:1024 sc1
    buffer_load_dwordx4 a[92:95], v213, s[8:11], s84 offen offset:2048 sc1
    s_add_u32 s84, s84, 3072
    buffer_load_dwordx4 a[96:99], v213, s[8:11], s84 offen offset:0 sc1
    buffer_load_dwordx4 a[100:103], v213, s[8:11], s84 offen offset:1024 sc1
    buffer_load_dwordx4 a[104:107], v213, s[8:11], s84 offen offset:2048 sc1
    s_add_u32 s84, s84, 3072
    buffer_load_dwordx4 a[108:111], v213, s[8:11], s84 offen offset:0 sc1
    buffer_load_dwordx4 a[112:115], v213, s[8:11], s84 offen offset:1024 sc1
    buffer_load_dwordx4 a[116:119], v213, s[8:11], s84 offen offset:2048 sc1
    s_add_u32 s84, s84, 3072
    buffer_load_dwordx4 a[120:123], v214, s[8:11], s84 offen offset:0 sc1
    buffer_load_dwordx4 a[124:127], v214, s[8:11], s84 offen offset:1024 sc1
    buffer_load_dwordx4 a[128:131], v214, s[8:11], s84 offen offset:2048 sc1
    s_add_u32 s84, s84, 3072
    buffer_load_dwordx4 a[132:135], v214, s[8:11], s84 offen offset:0 sc1
    buffer_load_dwordx4 a[136:139], v214, s[8:11], s84 offen offset:1024 sc1
    buffer_load_dwordx4 a[140:143], v214, s[8:11], s84 offen offset:2048 sc1
    s_add_u32 s84, s84, 3072
    buffer_load_dwordx4 a[144:147], v214, s[8:11], s84 offen offset:0 sc1
    buffer_load_dwordx4 a[148:151], v214, s[8:11], s84 offen offset:1024 sc1
    buffer_load_dwordx4 a[152:155], v214, s[8:11], s84 offen offset:2048 sc1
    s_add_u32 s84, s84, 3072
    buffer_load_dwordx4 a[156:159], v214, s[8:11], s84 offen offset:0 sc1
    buffer_load_dwordx4 a[160:163], v214, s[8:11], s84 offen offset:1024 sc1
    buffer_load_dwordx4 a[164:167], v214, s[8:11], s84 offen offset:2048 sc1
    s_add_u32 s84, s84, 3072
    s_mul_i32 s62, s5, 5
    s_lshr_b32 s62, s62, 2
    s_lshl_b32 s62, s62, 3
    v_add_u32 v14, s62, v0
    v_lshlrev_b32 v14, 6, v14
    s_mov_b32 s91, 24223744
    s_mul_i32 s62, s5, 3
    v_add_u32 v16, s62, v0
    v_lshlrev_b32 v16, 6, v16
    s_mov_b32 s92, 24313856
    s_mul_i32 s90, s3, 40
    v_add_u32 v18, s90, v0
    v_lshlrev_b32 v18, 4, v18
    s_and_b32 s90, s2, 7
    s_lshl_b32 s90, s90, 12
    s_add_u32 s90, s90, 24150016
    s_bfm_b64 exec, 16, 0
    buffer_load_dword v15, v14, s[8:11], s91 offen sc0 sc1
    s_mov_b64 exec, -1
    s_bfm_b64 exec, 3, 0
    buffer_load_dword v17, v16, s[8:11], s92 offen sc0 sc1
    s_mov_b64 exec, -1
    s_bfm_b64 exec, 40, 0
    buffer_load_dword v19, v18, s[8:11], s90 offen sc0 sc1
    s_mov_b64 exec, -1
    v_lshlrev_b32 v62, 4, v2
    v_lshlrev_b32 v63, 3, v2
    v_lshrrev_b32 v20, 2, v3
    v_lshl_add_u32 v20, v2, 3, v20
    v_lshlrev_b32 v20, 6, v20
    v_and_b32 v21, 3, v3
    v_lshl_add_u32 v20, v21, 3, v20
    v_and_b32 v21, 1, v2
    v_xor_b32 v21, s40, v21
    s_lshr_b32 s66, s3, 1
    s_mul_i32 s66, s66, 20480
    v_lshl_add_u32 v4, v21, 5, v20
    v_xor_b32 v21, 1, v21
    v_lshl_add_u32 v5, v21, 5, v20
    s_add_u32 s67, s66, 117760
    s_sub_u32 s68, 117760, s66
    v_add_u32 v6, s68, v4
    v_add_u32 v7, s68, v5
    v_add_u32 v4, s67, v4
    v_add_u32 v5, s67, v5
    v_mov_b32 v8, 0x3f803f80
    v_mov_b32 v9, 0x3f803f80
    v_mov_b32 v10, 0x3f803f80
    v_mov_b32 v11, 0x3f803f80
    s_mov_b32 s72, 0xbdd2d3e8
    s_mov_b32 s73, 0xbdd2d3e8
    v_mov_b32 v152, 0xc0135761
    v_mov_b32 v153, 0xc0135761
    v_mov_b32 v154, 1.0
    v_mov_b32 v155, 1.0
    s_lshl_b32 s77, s40, 3
    v_add_u32 v142, s77, v1
    v_add_u32 v251, 49152, v1
    v_lshrrev_b32 v210, 2, v0
    v_and_b32 v211, 3, v0
    v_lshrrev_b32 v212, 5, v0
    v_lshlrev_b32 v212, 1, v212
    v_xor_b32 v211, v211, v212
    v_lshlrev_b32 v211, 4, v211
    v_lshl_add_u32 v210, v210, 6, v211
    s_waitcnt vmcnt(2)
    s_bfm_b64 exec, 16, 0
    v_cmp_ne_u32 vcc, s12, v15
    s_mov_b64 exec, -1
    s_cbranch_vccz L_f_pok_35
    s_mov_b32 s13, 40000
L_f_pspin_36:
    s_bfm_b64 exec, 16, 0
    buffer_load_dword v15, v14, s[8:11], s91 offen sc0 sc1
    s_waitcnt vmcnt(0)
    v_cmp_ne_u32 vcc, s12, v15
    s_mov_b64 exec, -1
    s_cbranch_vccz L_f_pok_35
    s_sub_u32 s13, s13, 1
    s_cmp_eq_u32 s13, 0
    s_cbranch_scc1 L_bail
    s_branch L_f_pspin_36
L_f_pok_35:
    s_waitcnt vmcnt(1)
    s_bfm_b64 exec, 3, 0
    v_cmp_ne_u32 vcc, s12, v17
    s_mov_b64 exec, -1
    s_cbranch_vccz L_f_pok_37
    s_mov_b32 s13, 40000
L_f_pspin_38:
    s_bfm_b64 exec, 3, 0
    buffer_load_dword v17, v16, s[8:11], s92 offen sc0 sc1
    s_waitcnt vmcnt(0)
    v_cmp_ne_u32 vcc, s12, v17
    s_mov_b64 exec, -1
    s_cbranch_vccz L_f_pok_37
    s_sub_u32 s13, s13, 1
    s_cmp_eq_u32 s13, 0
    s_cbranch_scc1 L_bail
    s_branch L_f_pspin_38
L_f_pok_37:
    s_waitcnt vmcnt(0)
    s_bfm_b64 exec, 40, 0
    v_cmp_ne_u32 vcc, s12, v19
    s_mov_b64 exec, -1
    s_cbranch_vccz L_f_pok_39
    s_mov_b32 s13, 40000
L_f_pspin_40:
    s_bfm_b64 exec, 40, 0
    buffer_load_dword v19, v18, s[8:11], s90 offen sc0 sc1
    s_waitcnt vmcnt(0)
    v_cmp_ne_u32 vcc, s12, v19
    s_mov_b64 exec, -1
    s_cbranch_vccz L_f_pok_39
    s_sub_u32 s13, s13, 1
    s_cmp_eq_u32 s13, 0
    s_cbranch_scc1 L_bail
    s_branch L_f_pspin_40
L_f_pok_39:
    s_barrier
    s_add_u32 s87, s4, 0
    s_mul_i32 s87, s87, 40960
    s_lshl_b32 s88, s3, 11
    s_add_u32 s87, s87, s88
    s_add_u32 s87, s87, 7340032
    s_add_u32 s88, s88, 117760
    s_add_u32 m0, s88, 0
    s_add_u32 s89, s87, 0
    buffer_load_dwordx4 v210, s[8:11], s89 offen sc1 lds
    buffer_load_dwordx4 v210, s[8:11], s89 offen offset:1024 sc1 lds
    s_add_u32 m0, s88, 8192
    s_add_u32 s89, s87, 8192
    buffer_load_dwordx4 v210, s[8:11], s89 offen sc1 lds
    buffer_load_dwordx4 v210, s[8:11], s89 offen offset:1024 sc1 lds
    s_add_u32 m0, s88, 16384
    s_add_u32 s89, s87, 16384
    buffer_load_dwordx4 v210, s[8:11], s89 offen sc1 lds
    buffer_load_dwordx4 v210, s[8:11], s89 offen offset:1024 sc1 lds
    s_add_u32 m0, s88, 24576
    s_add_u32 s89, s87, 24576
    buffer_load_dwordx4 v210, s[8:11], s89 offen sc1 lds
    buffer_load_dwordx4 v210, s[8:11], s89 offen offset:1024 sc1 lds
    s_add_u32 m0, s88, 32768
    s_add_u32 s89, s87, 32768
    buffer_load_dwordx4 v210, s[8:11], s89 offen sc1 lds
    buffer_load_dwordx4 v210, s[8:11], s89 offen offset:1024 sc1 lds
    s_waitcnt vmcnt(0)
    s_barrier
L_p2:
    ds_read_b64_tr_b16 v[20:21], v4 offset:0
    ds_read_b64_tr_b16 v[22:23], v4 offset:256
    ds_read_b64_tr_b16 v[24:25], v5 offset:0
    ds_read_b64_tr_b16 v[26:27], v5 offset:256
    ds_read_b64_tr_b16 v[28:29], v4 offset:2048
    ds_read_b64_tr_b16 v[30:31], v4 offset:2304
    ds_read_b64_tr_b16 v[32:33], v5 offset:2048
    ds_read_b64_tr_b16 v[34:35], v5 offset:2304
    s_waitcnt lgkmcnt(4)
    v_mfma_f32_16x16x32_bf16 v[36:39], a[0:3], v[20:23], 0
    ds_read_b64_tr_b16 v[240:241], v4 offset:4096
    v_mfma_f32_16x16x32_bf16 v[40:43], a[0:3], v[24:27], 0
    ds_read_b64_tr_b16 v[242:243], v4 offset:4352
    v_mfma_f32_16x16x32_bf16 v[44:47], a[4:7], v[20:23], 0
    ds_read_b64_tr_b16 v[244:245], v5 offset:4096
    v_mfma_f32_16x16x32_bf16 v[48:51], a[4:7], v[24:27], 0
    ds_read_b64_tr_b16 v[246:247], v5 offset:4352
    v_mfma_f32_16x16x32_bf16 v[52:55], a[8:11], v[20:23], 0
    buffer_load_dwordx4 a[168:171], v214, s[8:11], s84 offen offset:0 sc1
    v_mfma_f32_16x16x32_bf16 v[56:59], a[8:11], v[24:27], 0
    buffer_load_dwordx4 a[172:175], v214, s[8:11], s84 offen offset:1024 sc1
    v_mfma_f32_16x16x32_bf16 v[12:15], v[20:23], v[20:23], 0
    v_mfma_f32_16x16x32_bf16 v[16:19], v[8:11], v[20:23], 0
    s_waitcnt lgkmcnt(4)
    v_mfma_f32_16x16x32_bf16 v[36:39], a[12:15], v[28:31], v[36:39]
    ds_read_b64_tr_b16 v[20:21], v4 offset:6144
    v_mfma_f32_16x16x32_bf16 v[40:43], a[12:15], v[32:35], v[40:43]
    ds_read_b64_tr_b16 v[22:23], v4 offset:6400
    v_mfma_f32_16x16x32_bf16 v[44:47], a[16:19], v[28:31], v[44:47]
    ds_read_b64_tr_b16 v[24:25], v5 offset:6144
    v_mfma_f32_16x16x32_bf16 v[48:51], a[16:19], v[32:35], v[48:51]
    ds_read_b64_tr_b16 v[26:27], v5 offset:6400
    v_mfma_f32_16x16x32_bf16 v[52:55], a[20:23], v[28:31], v[52:55]
    buffer_load_dwordx4 a[176:179], v214, s[8:11], s84 offen offset:2048 sc1
    s_add_u32 s84, s84, 3072
    v_mfma_f32_16x16x32_bf16 v[56:59], a[20:23], v[32:35], v[56:59]
    buffer_load_dwordx4 a[180:183], v214, s[8:11], s84 offen offset:0 sc1
    v_mfma_f32_16x16x32_bf16 v[12:15], v[28:31], v[28:31], v[12:15]
    v_mfma_f32_16x16x32_bf16 v[16:19], v[8:11], v[28:31], v[16:19]
    s_waitcnt lgkmcnt(4)
    v_mfma_f32_16x16x32_bf16 v[36:39], a[24:27], v[240:243], v[36:39]
    ds_read_b64_tr_b16 v[28:29], v4 offset:8192
    v_mfma_f32_16x16x32_bf16 v[40:43], a[24:27], v[244:247], v[40:43]
    ds_read_b64_tr_b16 v[30:31], v4 offset:8448
    v_mfma_f32_16x16x32_bf16 v[44:47], a[28:31], v[240:243], v[44:47]
    ds_read_b64_tr_b16 v[32:33], v5 offset:8192
    v_mfma_f32_16x16x32_bf16 v[48:51], a[28:31], v[244:247], v[48:51]
    ds_read_b64_tr_b16 v[34:35], v5 offset:8448
    v_mfma_f32_16x16x32_bf16 v[52:55], a[32:35], v[240:243], v[52:55]
    buffer_load_dwordx4 a[184:187], v214, s[8:11], s84 offen offset:1024 sc1
    v_mfma_f32_16x16x32_bf16 v[56:59], a[32:35], v[244:247], v[56:59]
    buffer_load_dwordx4 a[188:191], v214, s[8:11], s84 offen offset:2048 sc1
    s_add_u32 s84, s84, 3072
    v_mfma_f32_16x16x32_bf16 v[12:15], v[240:243], v[240:243], v[12:15]
    v_mfma_f32_16x16x32_bf16 v[16:19], v[8:11], v[240:243], v[16:19]
    s_waitcnt lgkmcnt(4)
    v_mfma_f32_16x16x32_bf16 v[36:39], a[36:39], v[20:23], v[36:39]
    ds_read_b64_tr_b16 v[240:241], v4 offset:10240
    v_mfma_f32_16x16x32_bf16 v[40:43], a[36:39], v[24:27], v[40:43]
    ds_read_b64_tr_b16 v[242:243], v4 offset:10496
    v_mfma_f32_16x16x32_bf16 v[44:47], a[40:43], v[20:23], v[44:47]
    ds_read_b64_tr_b16 v[244:245], v5 offset:10240
    v_mfma_f32_16x16x32_bf16 v[48:51], a[40:43], v[24:27], v[48:51]
    ds_read_b64_tr_b16 v[246:247], v5 offset:10496
    v_mfma_f32_16x16x32_bf16 v[52:55], a[44:47], v[20:23], v[52:55]
    buffer_load_dwordx4 a[192:195], v214, s[8:11], s84 offen offset:0 sc1
    v_mfma_f32_16x16x32_bf16 v[56:59], a[44:47], v[24:27], v[56:59]
    buffer_load_dwordx4 a[196:199], v214, s[8:11], s84 offen offset:1024 sc1
    v_mfma_f32_16x16x32_bf16 v[12:15], v[20:23], v[20:23], v[12:15]
    s_lshl_b32 s93, s41, 1
    s_add_u32 s93, s93, 14745600
    buffer_load_dwordx4 v[112:115], v62, s[8:11], s93 offen sc1
    v_mfma_f32_16x16x32_bf16 v[16:19], v[8:11], v[20:23], v[16:19]
    s_waitcnt lgkmcnt(4)
    v_mfma_f32_16x16x32_bf16 v[36:39], a[48:51], v[28:31], v[36:39]
    ds_read_b64_tr_b16 v[20:21], v4 offset:12288
    v_mfma_f32_16x16x32_bf16 v[40:43], a[48:51], v[32:35], v[40:43]
    ds_read_b64_tr_b16 v[22:23], v4 offset:12544
    v_mfma_f32_16x16x32_bf16 v[44:47], a[52:55], v[28:31], v[44:47]
    ds_read_b64_tr_b16 v[24:25], v5 offset:12288
    v_mfma_f32_16x16x32_bf16 v[48:51], a[52:55], v[32:35], v[48:51]
    ds_read_b64_tr_b16 v[26:27], v5 offset:12544
    v_mfma_f32_16x16x32_bf16 v[52:55], a[56:59], v[28:31], v[52:55]
    buffer_load_dwordx4 a[200:203], v214, s[8:11], s84 offen offset:2048 sc1
    s_add_u32 s84, s84, 3072
    v_mfma_f32_16x16x32_bf16 v[56:59], a[56:59], v[32:35], v[56:59]
    buffer_load_dwordx4 a[204:207], v214, s[8:11], s84 offen offset:0 sc1
    v_mfma_f32_16x16x32_bf16 v[12:15], v[28:31], v[28:31], v[12:15]
    buffer_load_dwordx2 v[124:125], v63, s[16:19], s41 offen
    v_mfma_f32_16x16x32_bf16 v[16:19], v[8:11], v[28:31], v[16:19]
    s_waitcnt lgkmcnt(4)
    v_mfma_f32_16x16x32_bf16 v[36:39], a[60:63], v[240:243], v[36:39]
    ds_read_b64_tr_b16 v[28:29], v4 offset:14336
    v_mfma_f32_16x16x32_bf16 v[40:43], a[60:63], v[244:247], v[40:43]
    ds_read_b64_tr_b16 v[30:31], v4 offset:14592
    v_mfma_f32_16x16x32_bf16 v[44:47], a[64:67], v[240:243], v[44:47]
    ds_read_b64_tr_b16 v[32:33], v5 offset:14336
    v_mfma_f32_16x16x32_bf16 v[48:51], a[64:67], v[244:247], v[48:51]
    ds_read_b64_tr_b16 v[34:35], v5 offset:14592
    v_mfma_f32_16x16x32_bf16 v[52:55], a[68:71], v[240:243], v[52:55]
    buffer_load_dwordx4 a[208:211], v214, s[8:11], s84 offen offset:1024 sc1
    v_mfma_f32_16x16x32_bf16 v[56:59], a[68:71], v[244:247], v[56:59]
    buffer_load_dwordx4 a[212:215], v214, s[8:11], s84 offen offset:2048 sc1
    s_add_u32 s84, s84, 3072
    v_mfma_f32_16x16x32_bf16 v[12:15], v[240:243], v[240:243], v[12:15]
    s_lshl_b32 s93, s58, 1
    s_add_u32 s93, s93, 14745600
    buffer_load_dwordx4 v[116:119], v62, s[8:11], s93 offen sc1
    v_mfma_f32_16x16x32_bf16 v[16:19], v[8:11], v[240:243], v[16:19]
    s_add_u32 m0, s51, 0
    s_add_u32 s47, s48, 0
    buffer_load_dwordx4 v1, s[8:11], s47 offen sc1 lds
    s_waitcnt lgkmcnt(4)
    v_mfma_f32_16x16x32_bf16 v[36:39], a[72:75], v[20:23], v[36:39]
    ds_read_b64_tr_b16 v[240:241], v4 offset:16384
    v_mfma_f32_16x16x32_bf16 v[40:43], a[72:75], v[24:27], v[40:43]
    ds_read_b64_tr_b16 v[242:243], v4 offset:16640
    v_mfma_f32_16x16x32_bf16 v[44:47], a[76:79], v[20:23], v[44:47]
    ds_read_b64_tr_b16 v[244:245], v5 offset:16384
    v_mfma_f32_16x16x32_bf16 v[48:51], a[76:79], v[24:27], v[48:51]
    ds_read_b64_tr_b16 v[246:247], v5 offset:16640
    v_mfma_f32_16x16x32_bf16 v[52:55], a[80:83], v[20:23], v[52:55]
    buffer_load_dwordx4 a[216:219], v214, s[8:11], s84 offen offset:0 sc1
    v_mfma_f32_16x16x32_bf16 v[56:59], a[80:83], v[24:27], v[56:59]
    buffer_load_dwordx4 a[220:223], v214, s[8:11], s84 offen offset:1024 sc1
    v_mfma_f32_16x16x32_bf16 v[12:15], v[20:23], v[20:23], v[12:15]
    buffer_load_dwordx2 v[126:127], v63, s[16:19], s58 offen
    v_mfma_f32_16x16x32_bf16 v[16:19], v[8:11], v[20:23], v[16:19]
    buffer_load_dwordx4 v1, s[8:11], s47 offen offset:1024 sc1 lds
    s_waitcnt lgkmcnt(4)
    v_mfma_f32_16x16x32_bf16 v[36:39], a[84:87], v[28:31], v[36:39]
    ds_read_b64_tr_b16 v[20:21], v4 offset:18432
    v_mfma_f32_16x16x32_bf16 v[40:43], a[84:87], v[32:35], v[40:43]
    ds_read_b64_tr_b16 v[22:23], v4 offset:18688
    v_mfma_f32_16x16x32_bf16 v[44:47], a[88:91], v[28:31], v[44:47]
    ds_read_b64_tr_b16 v[24:25], v5 offset:18432
    v_mfma_f32_16x16x32_bf16 v[48:51], a[88:91], v[32:35], v[48:51]
    ds_read_b64_tr_b16 v[26:27], v5 offset:18688
    v_mfma_f32_16x16x32_bf16 v[52:55], a[92:95], v[28:31], v[52:55]
    buffer_load_dwordx4 a[224:227], v214, s[8:11], s84 offen offset:2048 sc1
    s_add_u32 s84, s84, 3072
    v_mfma_f32_16x16x32_bf16 v[56:59], a[92:95], v[32:35], v[56:59]
    buffer_load_dwordx4 a[228:231], v214, s[8:11], s84 offen offset:0 sc1
    v_mfma_f32_16x16x32_bf16 v[12:15], v[28:31], v[28:31], v[12:15]
    s_lshl_b32 s93, s59, 1
    s_add_u32 s93, s93, 14745600
    buffer_load_dwordx4 v[120:123], v62, s[8:11], s93 offen sc1
    v_mfma_f32_16x16x32_bf16 v[16:19], v[8:11], v[28:31], v[16:19]
    buffer_load_dwordx4 v1, s[8:11], s47 offen offset:2048 sc1 lds
    s_waitcnt vmcnt(24)
    s_barrier
    s_cmp_ge_u32 s2, 160
    s_cbranch_scc1 L_f_nofb_41
    s_cmp_lg_u32 s3, 0
    s_cbranch_scc1 L_f_flag_42
    s_lshl_b32 s97, s2, 4
    s_add_u32 s97, s97, 24182784
    s_mov_b64 exec, 0xff
    v_mov_b32 v252, s12
    v_lshlrev_b32 v253, 12, v0
    buffer_store_dword v252, v253, s[8:11], s97 offen sc0 sc1
    s_mov_b64 exec, -1
L_f_flag_42:
L_f_nofb_41:
    s_waitcnt lgkmcnt(4)
    v_mfma_f32_16x16x32_bf16 v[36:39], a[96:99], v[240:243], v[36:39]
    ds_read_b64_tr_b16 v[28:29], v6 offset:20480
    v_mfma_f32_16x16x32_bf16 v[40:43], a[96:99], v[244:247], v[40:43]
    ds_read_b64_tr_b16 v[30:31], v6 offset:20736
    v_mfma_f32_16x16x32_bf16 v[44:47], a[100:103], v[240:243], v[44:47]
    ds_read_b64_tr_b16 v[32:33], v7 offset:20480
    v_mfma_f32_16x16x32_bf16 v[48:51], a[100:103], v[244:247], v[48:51]
    ds_read_b64_tr_b16 v[34:35], v7 offset:20736
    v_mfma_f32_16x16x32_bf16 v[52:55], a[104:107], v[240:243], v[52:55]
    buffer_load_dwordx4 a[232:235], v214, s[8:11], s84 offen offset:1024 sc1
    v_mfma_f32_16x16x32_bf16 v[56:59], a[104:107], v[244:247], v[56:59]
    buffer_load_dwordx4 a[236:239], v214, s[8:11], s84 offen offset:2048 sc1
    s_add_u32 s84, s84, 3072
    v_mfma_f32_16x16x32_bf16 v[12:15], v[240:243], v[240:243], v[12:15]
    buffer_load_dwordx2 v[128:129], v63, s[16:19], s59 offen
    v_mfma_f32_16x16x32_bf16 v[16:19], v[8:11], v[240:243], v[16:19]
    buffer_load_dwordx4 v1, s[8:11], s47 offen offset:3072 sc1 lds
    s_waitcnt lgkmcnt(4)
    v_mfma_f32_16x16x32_bf16 v[36:39], a[108:111], v[20:23], v[36:39]
    ds_read_b64_tr_b16 v[240:241], v6 offset:22528
    v_mfma_f32_16x16x32_bf16 v[40:43], a[108:111], v[24:27], v[40:43]
    ds_read_b64_tr_b16 v[242:243], v6 offset:22784
    v_mfma_f32_16x16x32_bf16 v[44:47], a[112:115], v[20:23], v[44:47]
    ds_read_b64_tr_b16 v[244:245], v7 offset:22528
    v_mfma_f32_16x16x32_bf16 v[48:51], a[112:115], v[24:27], v[48:51]
    ds_read_b64_tr_b16 v[246:247], v7 offset:22784
    v_mfma_f32_16x16x32_bf16 v[52:55], a[116:119], v[20:23], v[52:55]
    s_add_u32 m0, s51, 4096
    s_add_u32 s47, s48, 4096
    buffer_load_dwordx4 v1, s[8:11], s47 offen sc1 lds
    v_mfma_f32_16x16x32_bf16 v[56:59], a[116:119], v[24:27], v[56:59]
    v_mfma_f32_16x16x32_bf16 v[12:15], v[20:23], v[20:23], v[12:15]
    v_mfma_f32_16x16x32_bf16 v[16:19], v[8:11], v[20:23], v[16:19]
    s_waitcnt lgkmcnt(4)
    v_mfma_f32_16x16x32_bf16 v[36:39], a[120:123], v[28:31], v[36:39]
    ds_read_b64_tr_b16 v[20:21], v6 offset:24576
    v_mfma_f32_16x16x32_bf16 v[40:43], a[120:123], v[32:35], v[40:43]
    ds_read_b64_tr_b16 v[22:23], v6 offset:24832
    v_mfma_f32_16x16x32_bf16 v[44:47], a[124:127], v[28:31], v[44:47]
    ds_read_b64_tr_b16 v[24:25], v7 offset:24576
    v_mfma_f32_16x16x32_bf16 v[48:51], a[124:127], v[32:35], v[48:51]
    ds_read_b64_tr_b16 v[26:27], v7 offset:24832
    v_mfma_f32_16x16x32_bf16 v[52:55], a[128:131], v[28:31], v[52:55]
    buffer_load_dwordx4 v1, s[8:11], s47 offen offset:1024 sc1 lds
    v_mfma_f32_16x16x32_bf16 v[56:59], a[128:131], v[32:35], v[56:59]
    s_waitcnt lgkmcnt(4)
    v_mfma_f32_16x16x32_bf16 v[36:39], a[132:135], v[240:243], v[36:39]
    ds_read_b64_tr_b16 v[28:29], v6 offset:26624
    v_mfma_f32_16x16x32_bf16 v[40:43], a[132:135], v[244:247], v[40:43]
    ds_read_b64_tr_b16 v[30:31], v6 offset:26880
    v_mfma_f32_16x16x32_bf16 v[44:47], a[136:139], v[240:243], v[44:47]
    ds_read_b64_tr_b16 v[32:33], v7 offset:26624
    v_mfma_f32_16x16x32_bf16 v[48:51], a[136:139], v[244:247], v[48:51]
    ds_read_b64_tr_b16 v[34:35], v7 offset:26880
    v_mfma_f32_16x16x32_bf16 v[52:55], a[140:143], v[240:243], v[52:55]
    v_cndmask_b32 v221, v12, v13, s[32:33]
    v_mfma_f32_16x16x32_bf16 v[56:59], a[140:143], v[244:247], v[56:59]
    v_mov_b32 v220, v16
    v_cndmask_b32 v221, v221, v14, s[34:35]
    buffer_load_dwordx4 v1, s[8:11], s47 offen offset:2048 sc1 lds
    s_waitcnt vmcnt(4)
    s_waitcnt lgkmcnt(4)
    v_mfma_f32_16x16x32_bf16 v[36:39], a[144:147], v[20:23], v[36:39]
    ds_read_b64_tr_b16 v[240:241], v6 offset:28672
    v_mfma_f32_16x16x32_bf16 v[40:43], a[144:147], v[24:27], v[40:43]
    ds_read_b64_tr_b16 v[242:243], v6 offset:28928
    v_mfma_f32_16x16x32_bf16 v[44:47], a[148:151], v[20:23], v[44:47]
    ds_read_b64_tr_b16 v[244:245], v7 offset:28672
    v_mfma_f32_16x16x32_bf16 v[48:51], a[148:151], v[24:27], v[48:51]
    ds_read_b64_tr_b16 v[246:247], v7 offset:28928
    v_mfma_f32_16x16x32_bf16 v[52:55], a[152:155], v[20:23], v[52:55]
    v_lshlrev_b32 v130, 16, v124
    v_mfma_f32_16x16x32_bf16 v[56:59], a[152:155], v[24:27], v[56:59]
    v_and_b32 v131, 0xffff0000, v124
    v_lshlrev_b32 v132, 16, v125
    v_and_b32 v133, 0xffff0000, v125
    v_xor_b32 v222, 128, v235
    v_cndmask_b32 v221, v221, v15, s[36:37]
    s_mov_b64 exec, s[38:39]
    ds_write_b64 v234, v[220:221] offset:0
    s_mov_b64 exec, -1
    buffer_load_dwordx4 v1, s[8:11], s47 offen offset:3072 sc1 lds
    s_waitcnt lgkmcnt(5)
    v_mfma_f32_16x16x32_bf16 v[36:39], a[156:159], v[28:31], v[36:39]
    ds_read_b64_tr_b16 v[20:21], v6 offset:30720
    v_mfma_f32_16x16x32_bf16 v[40:43], a[156:159], v[32:35], v[40:43]
    ds_read_b64_tr_b16 v[22:23], v6 offset:30976
    v_mfma_f32_16x16x32_bf16 v[44:47], a[160:163], v[28:31], v[44:47]
    ds_read_b64_tr_b16 v[24:25], v7 offset:30720
    v_mfma_f32_16x16x32_bf16 v[48:51], a[160:163], v[32:35], v[48:51]
    ds_read_b64_tr_b16 v[26:27], v7 offset:30976
    v_mfma_f32_16x16x32_bf16 v[52:55], a[164:167], v[28:31], v[52:55]
    v_lshlrev_b32 v134, 16, v126
    v_mfma_f32_16x16x32_bf16 v[56:59], a[164:167], v[32:35], v[56:59]
    v_and_b32 v135, 0xffff0000, v126
    v_lshlrev_b32 v136, 16, v127
    v_and_b32 v137, 0xffff0000, v127
    s_waitcnt lgkmcnt(4)
    s_barrier
    ds_read_b64 v[226:227], v235 offset:0
    ds_read_b64 v[228:229], v235 offset:256
    ds_read_b64 v[230:231], v222 offset:0
    ds_read_b64 v[232:233], v222 offset:256
    s_add_u32 m0, s51, 8192
    s_add_u32 s47, s48, 8192
    buffer_load_dwordx4 v1, s[8:11], s47 offen sc1 lds
    v_mfma_f32_16x16x32_bf16 v[36:39], a[168:171], v[240:243], v[36:39]
    ds_read_b64_tr_b16 v[28:29], v6 offset:32768
    v_mfma_f32_16x16x32_bf16 v[40:43], a[168:171], v[244:247], v[40:43]
    ds_read_b64_tr_b16 v[30:31], v6 offset:33024
    v_mfma_f32_16x16x32_bf16 v[44:47], a[172:175], v[240:243], v[44:47]
    ds_read_b64_tr_b16 v[32:33], v7 offset:32768
    v_mfma_f32_16x16x32_bf16 v[48:51], a[172:175], v[244:247], v[48:51]
    ds_read_b64_tr_b16 v[34:35], v7 offset:33024
    v_mfma_f32_16x16x32_bf16 v[52:55], a[176:179], v[240:243], v[52:55]
    v_lshlrev_b32 v138, 16, v128
    v_mfma_f32_16x16x32_bf16 v[56:59], a[176:179], v[244:247], v[56:59]
    v_and_b32 v139, 0xffff0000, v128
    v_lshlrev_b32 v140, 16, v129
    v_and_b32 v141, 0xffff0000, v129
    s_mul_i32 s90, s3, 40
    v_add_u32 v60, s90, v0
    v_lshlrev_b32 v60, 4, v60
    s_and_b32 s90, s2, 7
    s_lshl_b32 s90, s90, 12
    s_add_u32 s90, s90, 24182784
    s_bfm_b64 exec, 40, 0
    buffer_load_dword v61, v60, s[8:11], s90 offen sc0 sc1
    s_mov_b64 exec, -1
    buffer_load_dwordx4 v1, s[8:11], s47 offen offset:1024 sc1 lds
    s_waitcnt lgkmcnt(8)
    v_mfma_f32_16x16x32_bf16 v[36:39], a[180:183], v[20:23], v[36:39]
    ds_read_b64_tr_b16 v[240:241], v6 offset:34816
    v_mfma_f32_16x16x32_bf16 v[40:43], a[180:183], v[24:27], v[40:43]
    ds_read_b64_tr_b16 v[242:243], v6 offset:35072
    v_mfma_f32_16x16x32_bf16 v[44:47], a[184:187], v[20:23], v[44:47]
    ds_read_b64_tr_b16 v[244:245], v7 offset:34816
    v_mfma_f32_16x16x32_bf16 v[48:51], a[184:187], v[24:27], v[48:51]
    ds_read_b64_tr_b16 v[246:247], v7 offset:35072
    v_mfma_f32_16x16x32_bf16 v[52:55], a[188:191], v[20:23], v[52:55]
    s_waitcnt lgkmcnt(8)
    v_mfma_f32_16x16x32_bf16 v[56:59], a[188:191], v[24:27], v[56:59]
    v_add_f32 v226, v226, v228
    v_add_f32 v230, v230, v232
    v_add_f32 v227, v227, v229
    v_add_f32 v231, v231, v233
    v_mul_f32 v226, 0x3acccccd, v226
    v_mul_f32 v230, 0x3acccccd, v230
    v_mul_f32 v227, 0x3acccccd, v227
    buffer_load_dwordx4 v1, s[8:11], s47 offen offset:2048 sc1 lds
    s_waitcnt lgkmcnt(4)
    v_mfma_f32_16x16x32_bf16 v[36:39], a[192:195], v[28:31], v[36:39]
    ds_read_b64_tr_b16 v[20:21], v6 offset:36864
    v_mfma_f32_16x16x32_bf16 v[40:43], a[192:195], v[32:35], v[40:43]
    ds_read_b64_tr_b16 v[22:23], v6 offset:37120
    v_mfma_f32_16x16x32_bf16 v[44:47], a[196:199], v[28:31], v[44:47]
    ds_read_b64_tr_b16 v[24:25], v7 offset:36864
    v_mfma_f32_16x16x32_bf16 v[48:51], a[196:199], v[32:35], v[48:51]
    ds_read_b64_tr_b16 v[26:27], v7 offset:37120
    v_mfma_f32_16x16x32_bf16 v[52:55], a[200:203], v[28:31], v[52:55]
    v_mul_f32 v231, 0x3acccccd, v231
    v_mfma_f32_16x16x32_bf16 v[56:59], a[200:203], v[32:35], v[56:59]
    v_fma_f32 v227, -v226, v226, v227
    v_fma_f32 v231, -v230, v230, v231
    v_max_f32 v227, 0, v227
    v_max_f32 v231, 0, v231
    v_cvt_pk_bf16_f32 v226, v226, v227
    v_cvt_pk_bf16_f32 v230, v230, v231
    v_and_b32 v227, 0xffff0000, v226
    buffer_load_dwordx4 v1, s[8:11], s47 offen offset:3072 sc1 lds
    s_waitcnt lgkmcnt(4)
    v_mfma_f32_16x16x32_bf16 v[36:39], a[204:207], v[240:243], v[36:39]
    ds_read_b64_tr_b16 v[28:29], v6 offset:38912
    v_mfma_f32_16x16x32_bf16 v[40:43], a[204:207], v[244:247], v[40:43]
    ds_read_b64_tr_b16 v[30:31], v6 offset:39168
    v_mfma_f32_16x16x32_bf16 v[44:47], a[208:211], v[240:243], v[44:47]
    ds_read_b64_tr_b16 v[32:33], v7 offset:38912
    v_mfma_f32_16x16x32_bf16 v[48:51], a[208:211], v[244:247], v[48:51]
    ds_read_b64_tr_b16 v[34:35], v7 offset:39168
    v_mfma_f32_16x16x32_bf16 v[52:55], a[212:215], v[240:243], v[52:55]
    v_and_b32 v231, 0xffff0000, v230
    v_mfma_f32_16x16x32_bf16 v[56:59], a[212:215], v[244:247], v[56:59]
    v_lshlrev_b32 v226, 16, v226
    v_lshlrev_b32 v230, 16, v230
    v_add_f32 v227, 0x3727c5ac, v227
    v_add_f32 v231, 0x3727c5ac, v231
    v_cvt_pk_bf16_f32 v227, v227, v227
    v_cvt_pk_bf16_f32 v231, v231, v231
    v_and_b32 v227, 0xffff0000, v227
    s_add_u32 m0, s51, 12288
    s_add_u32 s47, s48, 12288
    buffer_load_dwordx4 v1, s[8:11], s47 offen sc1 lds
    s_waitcnt lgkmcnt(4)
    v_mfma_f32_16x16x32_bf16 v[36:39], a[216:219], v[20:23], v[36:39]
    v_and_b32 v231, 0xffff0000, v231
    v_mfma_f32_16x16x32_bf16 v[40:43], a[216:219], v[24:27], v[40:43]
    v_sqrt_f32 v227, v227
    v_mfma_f32_16x16x32_bf16 v[44:47], a[220:223], v[20:23], v[44:47]
    v_sqrt_f32 v231, v231
    v_mfma_f32_16x16x32_bf16 v[48:51], a[220:223], v[24:27], v[48:51]
    s_nop 0
    v_mfma_f32_16x16x32_bf16 v[52:55], a[224:227], v[20:23], v[52:55]
    v_cvt_pk_bf16_f32 v227, v227, v227
    v_mfma_f32_16x16x32_bf16 v[56:59], a[224:227], v[24:27], v[56:59]
    v_cvt_pk_bf16_f32 v231, v231, v231
    v_and_b32 v227, 0xffff0000, v227
    v_and_b32 v231, 0xffff0000, v231
    buffer_load_dwordx4 v1, s[8:11], s47 offen offset:1024 sc1 lds
    ds_read_b64_tr_b16 a[240:241], v248 offset:0
    ds_read_b64_tr_b16 a[242:243], v248 offset:2048
    ds_read_b64_tr_b16 a[244:245], v248 offset:4096
    s_waitcnt lgkmcnt(3)
    v_mfma_f32_16x16x32_bf16 v[36:39], a[228:231], v[28:31], v[36:39]
    v_rcp_f32 v144, v227
    v_mfma_f32_16x16x32_bf16 v[40:43], a[228:231], v[32:35], v[40:43]
    v_rcp_f32 v146, v231
    v_mfma_f32_16x16x32_bf16 v[44:47], a[232:235], v[28:31], v[44:47]
    s_nop 0
    v_mfma_f32_16x16x32_bf16 v[48:51], a[232:235], v[32:35], v[48:51]
    v_mul_f32 v148, v226, v144
    v_mfma_f32_16x16x32_bf16 v[52:55], a[236:239], v[28:31], v[52:55]
    v_mul_f32 v150, v230, v146
    v_mfma_f32_16x16x32_bf16 v[56:59], a[236:239], v[32:35], v[56:59]
    v_sub_f32 v148, 0, v148
    v_sub_f32 v150, 0, v150
    buffer_load_dwordx4 v1, s[8:11], s47 offen offset:2048 sc1 lds
    s_waitcnt vmcnt(6)
    s_bfm_b64 exec, 40, 0
    v_cmp_ne_u32 vcc, s12, v61
    s_mov_b64 exec, -1
    s_cbranch_vccz L_f_pok_43
    s_mov_b32 s13, 40000
L_f_pspin_44:
    s_bfm_b64 exec, 40, 0
    buffer_load_dword v61, v60, s[8:11], s90 offen sc0 sc1
    s_waitcnt vmcnt(0)
    v_cmp_ne_u32 vcc, s12, v61
    s_mov_b64 exec, -1
    s_cbranch_vccz L_f_pok_43
    s_sub_u32 s13, s13, 1
    s_cmp_eq_u32 s13, 0
    s_cbranch_scc1 L_bail
    s_branch L_f_pspin_44
L_f_pok_43:
    s_waitcnt lgkmcnt(0)
    s_barrier
    v_pk_fma_f32 v[20:21], v[112:113], v[148:149], v[130:131] op_sel_hi:[1,0,1]
    v_pk_fma_f32 v[22:23], v[114:115], v[148:149], v[132:133] op_sel_hi:[1,0,1]
    v_pk_fma_f32 v[36:37], v[36:37], v[144:145], v[20:21] op_sel_hi:[1,0,1]
    v_pk_fma_f32 v[38:39], v[38:39], v[144:145], v[22:23] op_sel_hi:[1,0,1]
    v_pk_mul_f32 v[20:21], v[36:37], v[36:37]
    v_pk_mul_f32 v[22:23], v[38:39], v[38:39]
    s_add_u32 s87, s4, 32
    s_mul_i32 s87, s87, 40960
    s_lshl_b32 s88, s3, 11
    s_add_u32 s87, s87, s88
    s_add_u32 s87, s87, 7340032
    s_add_u32 s88, s88, 117760
    s_add_u32 m0, s88, 0
    s_add_u32 s89, s87, 0
    buffer_load_dwordx4 v210, s[8:11], s89 offen sc1 lds
    v_pk_fma_f32 v[20:21], v[20:21], s[72:73], v[152:153]
    v_pk_fma_f32 v[22:23], v[22:23], s[72:73], v[152:153]
    v_pk_mul_f32 v[20:21], v[20:21], v[36:37]
    v_pk_mul_f32 v[22:23], v[22:23], v[38:39]
    v_exp_f32 v20, v20
    v_exp_f32 v21, v21
    v_exp_f32 v22, v22
    v_exp_f32 v23, v23
    buffer_load_dwordx4 v210, s[8:11], s89 offen offset:1024 sc1 lds
    v_pk_add_f32 v[20:21], v[20:21], v[154:155]
    v_pk_add_f32 v[22:23], v[22:23], v[154:155]
    v_rcp_f32 v20, v20
    v_rcp_f32 v21, v21
    v_rcp_f32 v22, v22
    v_rcp_f32 v23, v23
    s_add_u32 m0, s88, 8192
    s_add_u32 s89, s87, 8192
    buffer_load_dwordx4 v210, s[8:11], s89 offen sc1 lds
    v_pk_mul_f32 v[20:21], v[20:21], v[36:37]
    v_pk_mul_f32 v[22:23], v[22:23], v[38:39]
    v_cvt_pk_bf16_f32 v156, v20, v21
    v_cvt_pk_bf16_f32 v157, v22, v23
    v_pk_fma_f32 v[20:21], v[116:117], v[148:149], v[134:135] op_sel_hi:[1,0,1]
    v_pk_fma_f32 v[22:23], v[118:119], v[148:149], v[136:137] op_sel_hi:[1,0,1]
    v_pk_fma_f32 v[44:45], v[44:45], v[144:145], v[20:21] op_sel_hi:[1,0,1]
    v_pk_fma_f32 v[46:47], v[46:47], v[144:145], v[22:23] op_sel_hi:[1,0,1]
    v_pk_mul_f32 v[20:21], v[44:45], v[44:45]
    v_pk_mul_f32 v[22:23], v[46:47], v[46:47]
    buffer_load_dwordx4 v210, s[8:11], s89 offen offset:1024 sc1 lds
    v_pk_fma_f32 v[20:21], v[20:21], s[72:73], v[152:153]
    v_pk_fma_f32 v[22:23], v[22:23], s[72:73], v[152:153]
    v_pk_mul_f32 v[20:21], v[20:21], v[44:45]
    v_pk_mul_f32 v[22:23], v[22:23], v[46:47]
    v_exp_f32 v20, v20
    v_exp_f32 v21, v21
    v_exp_f32 v22, v22
    v_exp_f32 v23, v23
    s_add_u32 m0, s88, 16384
    s_add_u32 s89, s87, 16384
    buffer_load_dwordx4 v210, s[8:11], s89 offen sc1 lds
    v_pk_add_f32 v[20:21], v[20:21], v[154:155]
    v_pk_add_f32 v[22:23], v[22:23], v[154:155]
    v_rcp_f32 v20, v20
    v_rcp_f32 v21, v21
    v_rcp_f32 v22, v22
    v_rcp_f32 v23, v23
    buffer_load_dwordx4 v210, s[8:11], s89 offen offset:1024 sc1 lds
    v_pk_mul_f32 v[20:21], v[20:21], v[44:45]
    v_pk_mul_f32 v[22:23], v[22:23], v[46:47]
    v_cvt_pk_bf16_f32 v158, v20, v21
    v_cvt_pk_bf16_f32 v159, v22, v23
    v_pk_fma_f32 v[20:21], v[120:121], v[148:149], v[138:139] op_sel_hi:[1,0,1]
    v_pk_fma_f32 v[22:23], v[122:123], v[148:149], v[140:141] op_sel_hi:[1,0,1]
    v_pk_fma_f32 v[52:53], v[52:53], v[144:145], v[20:21] op_sel_hi:[1,0,1]
    v_pk_fma_f32 v[54:55], v[54:55], v[144:145], v[22:23] op_sel_hi:[1,0,1]
    v_pk_mul_f32 v[20:21], v[52:53], v[52:53]
    v_pk_mul_f32 v[22:23], v[54:55], v[54:55]
    s_add_u32 m0, s88, 24576
    s_add_u32 s89, s87, 24576
    buffer_load_dwordx4 v210, s[8:11], s89 offen sc1 lds
    v_pk_fma_f32 v[20:21], v[20:21], s[72:73], v[152:153]
    v_pk_fma_f32 v[22:23], v[22:23], s[72:73], v[152:153]
    v_pk_mul_f32 v[20:21], v[20:21], v[52:53]
    v_pk_mul_f32 v[22:23], v[22:23], v[54:55]
    v_exp_f32 v20, v20
    v_exp_f32 v21, v21
    v_exp_f32 v22, v22
    v_exp_f32 v23, v23
    buffer_load_dwordx4 v210, s[8:11], s89 offen offset:1024 sc1 lds
    v_pk_add_f32 v[20:21], v[20:21], v[154:155]
    v_pk_add_f32 v[22:23], v[22:23], v[154:155]
    v_rcp_f32 v20, v20
    v_rcp_f32 v21, v21
    v_rcp_f32 v22, v22
    v_rcp_f32 v23, v23
    s_add_u32 m0, s88, 32768
    s_add_u32 s89, s87, 32768
    buffer_load_dwordx4 v210, s[8:11], s89 offen sc1 lds
    v_pk_mul_f32 v[20:21], v[20:21], v[52:53]
    v_pk_mul_f32 v[22:23], v[22:23], v[54:55]
    v_cvt_pk_bf16_f32 v160, v20, v21
    v_cvt_pk_bf16_f32 v161, v22, v23
    buffer_store_dwordx4 v[156:159], v1, s[8:11], s52 offen sc0 sc1
    buffer_store_dwordx2 v[160:161], v142, s[8:11], s53 offen sc0 sc1
    v_pk_fma_f32 v[20:21], v[112:113], v[150:151], v[130:131] op_sel_hi:[1,0,1]
    v_pk_fma_f32 v[22:23], v[114:115], v[150:151], v[132:133] op_sel_hi:[1,0,1]
    v_pk_fma_f32 v[40:41], v[40:41], v[146:147], v[20:21] op_sel_hi:[1,0,1]
    v_pk_fma_f32 v[42:43], v[42:43], v[146:147], v[22:23] op_sel_hi:[1,0,1]
    v_pk_mul_f32 v[20:21], v[40:41], v[40:41]
    v_pk_mul_f32 v[22:23], v[42:43], v[42:43]
    buffer_load_dwordx4 v210, s[8:11], s89 offen offset:1024 sc1 lds
    v_pk_fma_f32 v[20:21], v[20:21], s[72:73], v[152:153]
    v_pk_fma_f32 v[22:23], v[22:23], s[72:73], v[152:153]
    v_pk_mul_f32 v[20:21], v[20:21], v[40:41]
    v_pk_mul_f32 v[22:23], v[22:23], v[42:43]
    v_exp_f32 v20, v20
    v_exp_f32 v21, v21
    v_exp_f32 v22, v22
    v_exp_f32 v23, v23
    s_nop 0
    v_pk_add_f32 v[20:21], v[20:21], v[154:155]
    v_pk_add_f32 v[22:23], v[22:23], v[154:155]
    v_rcp_f32 v20, v20
    v_rcp_f32 v21, v21
    v_rcp_f32 v22, v22
    v_rcp_f32 v23, v23
    s_nop 0
    v_pk_mul_f32 v[20:21], v[20:21], v[40:41]
    v_pk_mul_f32 v[22:23], v[22:23], v[42:43]
    v_cvt_pk_bf16_f32 v164, v20, v21
    v_cvt_pk_bf16_f32 v165, v22, v23
    v_pk_fma_f32 v[20:21], v[116:117], v[150:151], v[134:135] op_sel_hi:[1,0,1]
    v_pk_fma_f32 v[22:23], v[118:119], v[150:151], v[136:137] op_sel_hi:[1,0,1]
    v_pk_fma_f32 v[48:49], v[48:49], v[146:147], v[20:21] op_sel_hi:[1,0,1]
    v_pk_fma_f32 v[50:51], v[50:51], v[146:147], v[22:23] op_sel_hi:[1,0,1]
    v_pk_mul_f32 v[20:21], v[48:49], v[48:49]
    v_pk_mul_f32 v[22:23], v[50:51], v[50:51]
    v_pk_fma_f32 v[20:21], v[20:21], s[72:73], v[152:153]
    v_pk_fma_f32 v[22:23], v[22:23], s[72:73], v[152:153]
    v_pk_mul_f32 v[20:21], v[20:21], v[48:49]
    v_pk_mul_f32 v[22:23], v[22:23], v[50:51]
    v_exp_f32 v20, v20
    v_exp_f32 v21, v21
    v_exp_f32 v22, v22
    v_exp_f32 v23, v23
    s_nop 0
    v_pk_add_f32 v[20:21], v[20:21], v[154:155]
    v_pk_add_f32 v[22:23], v[22:23], v[154:155]
    v_rcp_f32 v20, v20
    v_rcp_f32 v21, v21
    v_rcp_f32 v22, v22
    v_rcp_f32 v23, v23
    s_nop 0
    v_pk_mul_f32 v[20:21], v[20:21], v[48:49]
    v_pk_mul_f32 v[22:23], v[22:23], v[50:51]
    v_cvt_pk_bf16_f32 v166, v20, v21
    v_cvt_pk_bf16_f32 v167, v22, v23
    v_pk_fma_f32 v[20:21], v[120:121], v[150:151], v[138:139] op_sel_hi:[1,0,1]
    v_pk_fma_f32 v[22:23], v[122:123], v[150:151], v[140:141] op_sel_hi:[1,0,1]
    v_pk_fma_f32 v[56:57], v[56:57], v[146:147], v[20:21] op_sel_hi:[1,0,1]
    v_pk_fma_f32 v[58:59], v[58:59], v[146:147], v[22:23] op_sel_hi:[1,0,1]
    v_pk_mul_f32 v[20:21], v[56:57], v[56:57]
    v_pk_mul_f32 v[22:23], v[58:59], v[58:59]
    v_pk_fma_f32 v[20:21], v[20:21], s[72:73], v[152:153]
    v_pk_fma_f32 v[22:23], v[22:23], s[72:73], v[152:153]
    v_pk_mul_f32 v[20:21], v[20:21], v[56:57]
    v_pk_mul_f32 v[22:23], v[22:23], v[58:59]
    v_exp_f32 v20, v20
    v_exp_f32 v21, v21
    v_exp_f32 v22, v22
    v_exp_f32 v23, v23
    s_nop 0
    v_pk_add_f32 v[20:21], v[20:21], v[154:155]
    v_pk_add_f32 v[22:23], v[22:23], v[154:155]
    v_rcp_f32 v20, v20
    v_rcp_f32 v21, v21
    v_rcp_f32 v22, v22
    v_rcp_f32 v23, v23
    s_nop 0
    v_pk_mul_f32 v[20:21], v[20:21], v[56:57]
    v_pk_mul_f32 v[22:23], v[22:23], v[58:59]
    v_cvt_pk_bf16_f32 v168, v20, v21
    v_cvt_pk_bf16_f32 v169, v22, v23
    buffer_store_dwordx4 v[164:167], v1, s[8:11], s54 offen sc0 sc1
    buffer_store_dwordx2 v[168:169], v142, s[8:11], s55 offen sc0 sc1
    s_waitcnt vmcnt(2)
    s_barrier
    s_add_u32 s52, s52, 3145728
    s_add_u32 s53, s53, 3145728
    s_add_u32 s54, s54, 3145728
    s_add_u32 s55, s55, 3145728
    ds_read_b64_tr_b16 v[20:21], v4 offset:0
    ds_read_b64_tr_b16 v[22:23], v4 offset:256
    ds_read_b64_tr_b16 v[24:25], v5 offset:0
    ds_read_b64_tr_b16 v[26:27], v5 offset:256
    ds_read_b64_tr_b16 v[28:29], v4 offset:2048
    ds_read_b64_tr_b16 v[30:31], v4 offset:2304
    ds_read_b64_tr_b16 v[32:33], v5 offset:2048
    ds_read_b64_tr_b16 v[34:35], v5 offset:2304
    s_waitcnt lgkmcnt(4)
    v_mfma_f32_16x16x32_bf16 v[36:39], a[0:3], v[20:23], 0
    ds_read_b64_tr_b16 v[240:241], v4 offset:4096
    v_mfma_f32_16x16x32_bf16 v[40:43], a[0:3], v[24:27], 0
    ds_read_b64_tr_b16 v[242:243], v4 offset:4352
    v_mfma_f32_16x16x32_bf16 v[44:47], a[4:7], v[20:23], 0
    ds_read_b64_tr_b16 v[244:245], v5 offset:4096
    v_mfma_f32_16x16x32_bf16 v[48:51], a[4:7], v[24:27], 0
    ds_read_b64_tr_b16 v[246:247], v5 offset:4352
    v_mfma_f32_16x16x32_bf16 v[52:55], a[8:11], v[20:23], 0
    v_mfma_f32_16x16x32_bf16 v[56:59], a[8:11], v[24:27], 0
    v_mfma_f32_16x16x32_bf16 v[12:15], v[20:23], v[20:23], 0
    v_mfma_f32_16x16x32_bf16 v[16:19], v[8:11], v[20:23], 0
    s_waitcnt lgkmcnt(4)
    v_mfma_f32_16x16x32_bf16 v[36:39], a[12:15], v[28:31], v[36:39]
    ds_read_b64_tr_b16 v[20:21], v4 offset:6144
    v_mfma_f32_16x16x32_bf16 v[40:43], a[12:15], v[32:35], v[40:43]
    ds_read_b64_tr_b16 v[22:23], v4 offset:6400
    v_mfma_f32_16x16x32_bf16 v[44:47], a[16:19], v[28:31], v[44:47]
    ds_read_b64_tr_b16 v[24:25], v5 offset:6144
    v_mfma_f32_16x16x32_bf16 v[48:51], a[16:19], v[32:35], v[48:51]
    ds_read_b64_tr_b16 v[26:27], v5 offset:6400
    v_mfma_f32_16x16x32_bf16 v[52:55], a[20:23], v[28:31], v[52:55]
    buffer_load_dwordx4 a[0:3], v1, s[8:11], s57 offen offset:0 sc1
    v_mfma_f32_16x16x32_bf16 v[56:59], a[20:23], v[32:35], v[56:59]
    buffer_load_dwordx4 a[4:7], v1, s[8:11], s57 offen offset:1024 sc1
    v_mfma_f32_16x16x32_bf16 v[12:15], v[28:31], v[28:31], v[12:15]
    v_mfma_f32_16x16x32_bf16 v[16:19], v[8:11], v[28:31], v[16:19]
    s_waitcnt lgkmcnt(4)
    v_mfma_f32_16x16x32_bf16 v[36:39], a[24:27], v[240:243], v[36:39]
    ds_read_b64_tr_b16 v[28:29], v4 offset:8192
    v_mfma_f32_16x16x32_bf16 v[40:43], a[24:27], v[244:247], v[40:43]
    ds_read_b64_tr_b16 v[30:31], v4 offset:8448
    v_mfma_f32_16x16x32_bf16 v[44:47], a[28:31], v[240:243], v[44:47]
    ds_read_b64_tr_b16 v[32:33], v5 offset:8192
    v_mfma_f32_16x16x32_bf16 v[48:51], a[28:31], v[244:247], v[48:51]
    ds_read_b64_tr_b16 v[34:35], v5 offset:8448
    v_mfma_f32_16x16x32_bf16 v[52:55], a[32:35], v[240:243], v[52:55]
    buffer_load_dwordx4 a[8:11], v1, s[8:11], s57 offen offset:2048 sc1
    v_mfma_f32_16x16x32_bf16 v[56:59], a[32:35], v[244:247], v[56:59]
    buffer_load_dwordx4 a[12:15], v1, s[8:11], s57 offen offset:3072 sc1
    s_add_u32 s57, s57, 4096
    v_mfma_f32_16x16x32_bf16 v[12:15], v[240:243], v[240:243], v[12:15]
    v_mfma_f32_16x16x32_bf16 v[16:19], v[8:11], v[240:243], v[16:19]
    s_waitcnt lgkmcnt(4)
    v_mfma_f32_16x16x32_bf16 v[36:39], a[36:39], v[20:23], v[36:39]
    ds_read_b64_tr_b16 v[240:241], v4 offset:10240
    v_mfma_f32_16x16x32_bf16 v[40:43], a[36:39], v[24:27], v[40:43]
    ds_read_b64_tr_b16 v[242:243], v4 offset:10496
    v_mfma_f32_16x16x32_bf16 v[44:47], a[40:43], v[20:23], v[44:47]
    ds_read_b64_tr_b16 v[244:245], v5 offset:10240
    v_mfma_f32_16x16x32_bf16 v[48:51], a[40:43], v[24:27], v[48:51]
    ds_read_b64_tr_b16 v[246:247], v5 offset:10496
    v_mfma_f32_16x16x32_bf16 v[52:55], a[44:47], v[20:23], v[52:55]
    buffer_load_dwordx4 a[16:19], v1, s[8:11], s57 offen offset:0 sc1
    v_mfma_f32_16x16x32_bf16 v[56:59], a[44:47], v[24:27], v[56:59]
    buffer_load_dwordx4 a[20:23], v1, s[8:11], s57 offen offset:1024 sc1
    v_mfma_f32_16x16x32_bf16 v[12:15], v[20:23], v[20:23], v[12:15]
    v_mfma_f32_16x16x32_bf16 v[16:19], v[8:11], v[20:23], v[16:19]
    s_waitcnt vmcnt(6)
    s_barrier
    s_lshl_b32 s66, s2, 6
    s_add_u32 s66, s66, 24231936
    s_cmp_lg_u32 s3, 0
    s_cbranch_scc1 L_f_flag_45
    s_mov_b64 exec, 1
    v_mov_b32 v252, s12
    v_mov_b32 v253, 0
    buffer_store_dword v252, v253, s[8:11], s66 offen sc0 sc1
    s_mov_b64 exec, -1
L_f_flag_45:
    s_waitcnt lgkmcnt(4)
    v_mfma_f32_16x16x32_bf16 v[36:39], a[48:51], v[28:31], v[36:39]
    ds_read_b64_tr_b16 v[20:21], v4 offset:12288
    v_mfma_f32_16x16x32_bf16 v[40:43], a[48:51], v[32:35], v[40:43]
    ds_read_b64_tr_b16 v[22:23], v4 offset:12544
    v_mfma_f32_16x16x32_bf16 v[44:47], a[52:55], v[28:31], v[44:47]
    ds_read_b64_tr_b16 v[24:25], v5 offset:12288
    v_mfma_f32_16x16x32_bf16 v[48:51], a[52:55], v[32:35], v[48:51]
    ds_read_b64_tr_b16 v[26:27], v5 offset:12544
    v_mfma_f32_16x16x32_bf16 v[52:55], a[56:59], v[28:31], v[52:55]
    buffer_load_dwordx4 a[24:27], v1, s[8:11], s57 offen offset:2048 sc1
    v_mfma_f32_16x16x32_bf16 v[56:59], a[56:59], v[32:35], v[56:59]
    buffer_load_dwordx4 a[28:31], v1, s[8:11], s57 offen offset:3072 sc1
    s_add_u32 s57, s57, 4096
    v_mfma_f32_16x16x32_bf16 v[12:15], v[28:31], v[28:31], v[12:15]
    v_mfma_f32_16x16x32_bf16 v[16:19], v[8:11], v[28:31], v[16:19]
    s_waitcnt lgkmcnt(4)
    v_mfma_f32_16x16x32_bf16 v[36:39], a[60:63], v[240:243], v[36:39]
    ds_read_b64_tr_b16 v[28:29], v4 offset:14336
    v_mfma_f32_16x16x32_bf16 v[40:43], a[60:63], v[244:247], v[40:43]
    ds_read_b64_tr_b16 v[30:31], v4 offset:14592
    v_mfma_f32_16x16x32_bf16 v[44:47], a[64:67], v[240:243], v[44:47]
    ds_read_b64_tr_b16 v[32:33], v5 offset:14336
    v_mfma_f32_16x16x32_bf16 v[48:51], a[64:67], v[244:247], v[48:51]
    ds_read_b64_tr_b16 v[34:35], v5 offset:14592
    v_mfma_f32_16x16x32_bf16 v[52:55], a[68:71], v[240:243], v[52:55]
    buffer_load_dwordx4 a[32:35], v1, s[8:11], s57 offen offset:0 sc1
    v_mfma_f32_16x16x32_bf16 v[56:59], a[68:71], v[244:247], v[56:59]
    buffer_load_dwordx4 a[36:39], v1, s[8:11], s57 offen offset:1024 sc1
    v_mfma_f32_16x16x32_bf16 v[12:15], v[240:243], v[240:243], v[12:15]
    v_mfma_f32_16x16x32_bf16 v[16:19], v[8:11], v[240:243], v[16:19]
    s_waitcnt lgkmcnt(4)
    v_mfma_f32_16x16x32_bf16 v[36:39], a[72:75], v[20:23], v[36:39]
    ds_read_b64_tr_b16 v[240:241], v4 offset:16384
    v_mfma_f32_16x16x32_bf16 v[40:43], a[72:75], v[24:27], v[40:43]
    ds_read_b64_tr_b16 v[242:243], v4 offset:16640
    v_mfma_f32_16x16x32_bf16 v[44:47], a[76:79], v[20:23], v[44:47]
    ds_read_b64_tr_b16 v[244:245], v5 offset:16384
    v_mfma_f32_16x16x32_bf16 v[48:51], a[76:79], v[24:27], v[48:51]
    ds_read_b64_tr_b16 v[246:247], v5 offset:16640
    v_mfma_f32_16x16x32_bf16 v[52:55], a[80:83], v[20:23], v[52:55]
    buffer_load_dwordx4 a[40:43], v1, s[8:11], s57 offen offset:2048 sc1
    v_mfma_f32_16x16x32_bf16 v[56:59], a[80:83], v[24:27], v[56:59]
    buffer_load_dwordx4 a[44:47], v1, s[8:11], s57 offen offset:3072 sc1
    s_add_u32 s57, s57, 4096
    v_mfma_f32_16x16x32_bf16 v[12:15], v[20:23], v[20:23], v[12:15]
    v_mfma_f32_16x16x32_bf16 v[16:19], v[8:11], v[20:23], v[16:19]
    s_waitcnt lgkmcnt(4)
    v_mfma_f32_16x16x32_bf16 v[36:39], a[84:87], v[28:31], v[36:39]
    ds_read_b64_tr_b16 v[20:21], v4 offset:18432
    v_mfma_f32_16x16x32_bf16 v[40:43], a[84:87], v[32:35], v[40:43]
    ds_read_b64_tr_b16 v[22:23], v4 offset:18688
    v_mfma_f32_16x16x32_bf16 v[44:47], a[88:91], v[28:31], v[44:47]
    ds_read_b64_tr_b16 v[24:25], v5 offset:18432
    v_mfma_f32_16x16x32_bf16 v[48:51], a[88:91], v[32:35], v[48:51]
    ds_read_b64_tr_b16 v[26:27], v5 offset:18688
    v_mfma_f32_16x16x32_bf16 v[52:55], a[92:95], v[28:31], v[52:55]
    buffer_load_dwordx4 a[48:51], v1, s[8:11], s57 offen offset:0 sc1
    v_mfma_f32_16x16x32_bf16 v[56:59], a[92:95], v[32:35], v[56:59]
    buffer_load_dwordx4 a[52:55], v1, s[8:11], s57 offen offset:1024 sc1
    v_mfma_f32_16x16x32_bf16 v[12:15], v[28:31], v[28:31], v[12:15]
    v_mfma_f32_16x16x32_bf16 v[16:19], v[8:11], v[28:31], v[16:19]
    s_waitcnt lgkmcnt(4)
    v_mfma_f32_16x16x32_bf16 v[36:39], a[96:99], v[240:243], v[36:39]
    ds_read_b64_tr_b16 v[28:29], v6 offset:20480
    v_mfma_f32_16x16x32_bf16 v[40:43], a[96:99], v[244:247], v[40:43]
    ds_read_b64_tr_b16 v[30:31], v6 offset:20736
    v_mfma_f32_16x16x32_bf16 v[44:47], a[100:103], v[240:243], v[44:47]
    ds_read_b64_tr_b16 v[32:33], v7 offset:20480
    v_mfma_f32_16x16x32_bf16 v[48:51], a[100:103], v[244:247], v[48:51]
    ds_read_b64_tr_b16 v[34:35], v7 offset:20736
    v_mfma_f32_16x16x32_bf16 v[52:55], a[104:107], v[240:243], v[52:55]
    buffer_load_dwordx4 a[56:59], v1, s[8:11], s57 offen offset:2048 sc1
    v_mfma_f32_16x16x32_bf16 v[56:59], a[104:107], v[244:247], v[56:59]
    buffer_load_dwordx4 a[60:63], v1, s[8:11], s57 offen offset:3072 sc1
    s_add_u32 s57, s57, 4096
    v_mfma_f32_16x16x32_bf16 v[12:15], v[240:243], v[240:243], v[12:15]
    v_mfma_f32_16x16x32_bf16 v[16:19], v[8:11], v[240:243], v[16:19]
    s_waitcnt lgkmcnt(4)
    v_mfma_f32_16x16x32_bf16 v[36:39], a[108:111], v[20:23], v[36:39]
    ds_read_b64_tr_b16 v[240:241], v6 offset:22528
    v_mfma_f32_16x16x32_bf16 v[40:43], a[108:111], v[24:27], v[40:43]
    ds_read_b64_tr_b16 v[242:243], v6 offset:22784
    v_mfma_f32_16x16x32_bf16 v[44:47], a[112:115], v[20:23], v[44:47]
    ds_read_b64_tr_b16 v[244:245], v7 offset:22528
    v_mfma_f32_16x16x32_bf16 v[48:51], a[112:115], v[24:27], v[48:51]
    ds_read_b64_tr_b16 v[246:247], v7 offset:22784
    v_mfma_f32_16x16x32_bf16 v[52:55], a[116:119], v[20:23], v[52:55]
    buffer_load_dwordx4 a[64:67], v1, s[8:11], s57 offen offset:0 sc1
    v_mfma_f32_16x16x32_bf16 v[56:59], a[116:119], v[24:27], v[56:59]
    buffer_load_dwordx4 a[68:71], v1, s[8:11], s57 offen offset:1024 sc1
    v_mfma_f32_16x16x32_bf16 v[12:15], v[20:23], v[20:23], v[12:15]
    v_mfma_f32_16x16x32_bf16 v[16:19], v[8:11], v[20:23], v[16:19]
    s_waitcnt lgkmcnt(4)
    v_mfma_f32_16x16x32_bf16 v[36:39], a[120:123], v[28:31], v[36:39]
    ds_read_b64_tr_b16 v[20:21], v6 offset:24576
    v_mfma_f32_16x16x32_bf16 v[40:43], a[120:123], v[32:35], v[40:43]
    ds_read_b64_tr_b16 v[22:23], v6 offset:24832
    v_mfma_f32_16x16x32_bf16 v[44:47], a[124:127], v[28:31], v[44:47]
    ds_read_b64_tr_b16 v[24:25], v7 offset:24576
    v_mfma_f32_16x16x32_bf16 v[48:51], a[124:127], v[32:35], v[48:51]
    ds_read_b64_tr_b16 v[26:27], v7 offset:24832
    v_mfma_f32_16x16x32_bf16 v[52:55], a[128:131], v[28:31], v[52:55]
    buffer_load_dwordx4 a[72:75], v1, s[8:11], s57 offen offset:2048 sc1
    v_mfma_f32_16x16x32_bf16 v[56:59], a[128:131], v[32:35], v[56:59]
    buffer_load_dwordx4 a[76:79], v1, s[8:11], s57 offen offset:3072 sc1
    s_add_u32 s57, s57, 4096
    s_waitcnt lgkmcnt(4)
    v_mfma_f32_16x16x32_bf16 v[36:39], a[132:135], v[240:243], v[36:39]
    ds_read_b64_tr_b16 v[28:29], v6 offset:26624
    v_mfma_f32_16x16x32_bf16 v[40:43], a[132:135], v[244:247], v[40:43]
    ds_read_b64_tr_b16 v[30:31], v6 offset:26880
    v_mfma_f32_16x16x32_bf16 v[44:47], a[136:139], v[240:243], v[44:47]
    ds_read_b64_tr_b16 v[32:33], v7 offset:26624
    v_mfma_f32_16x16x32_bf16 v[48:51], a[136:139], v[244:247], v[48:51]
    ds_read_b64_tr_b16 v[34:35], v7 offset:26880
    v_mfma_f32_16x16x32_bf16 v[52:55], a[140:143], v[240:243], v[52:55]
    buffer_load_dwordx4 a[80:83], v1, s[8:11], s57 offen offset:0 sc1
    v_mfma_f32_16x16x32_bf16 v[56:59], a[140:143], v[244:247], v[56:59]
    buffer_load_dwordx4 a[84:87], v1, s[8:11], s57 offen offset:1024 sc1
    v_cndmask_b32 v221, v12, v13, s[32:33]
    v_mov_b32 v220, v16
    v_cndmask_b32 v221, v221, v14, s[34:35]
    s_waitcnt lgkmcnt(4)
    v_mfma_f32_16x16x32_bf16 v[36:39], a[144:147], v[20:23], v[36:39]
    ds_read_b64_tr_b16 v[240:241], v6 offset:28672
    v_mfma_f32_16x16x32_bf16 v[40:43], a[144:147], v[24:27], v[40:43]
    ds_read_b64_tr_b16 v[242:243], v6 offset:28928
    v_mfma_f32_16x16x32_bf16 v[44:47], a[148:151], v[20:23], v[44:47]
    ds_read_b64_tr_b16 v[244:245], v7 offset:28672
    v_mfma_f32_16x16x32_bf16 v[48:51], a[148:151], v[24:27], v[48:51]
    ds_read_b64_tr_b16 v[246:247], v7 offset:28928
    v_mfma_f32_16x16x32_bf16 v[52:55], a[152:155], v[20:23], v[52:55]
    buffer_load_dwordx4 a[88:91], v1, s[8:11], s57 offen offset:2048 sc1
    v_mfma_f32_16x16x32_bf16 v[56:59], a[152:155], v[24:27], v[56:59]
    buffer_load_dwordx4 a[92:95], v1, s[8:11], s57 offen offset:3072 sc1
    s_add_u32 s57, s57, 4096
    s_and_b32 s66, s2, 0x3e
    v_and_b32 v60, 1, v0
    v_bfe_u32 v61, v0, 1, 2
    v_lshl_add_u32 v60, v61, 6, v60
    v_add_u32 v60, s66, v60
    v_lshlrev_b32 v60, 6, v60
    s_mov_b32 s94, 24231936
    s_bfm_b64 exec, 8, 0
    buffer_load_dword v61, v60, s[8:11], s94 offen sc0 sc1
    s_mov_b64 exec, -1
    v_xor_b32 v222, 128, v235
    v_cndmask_b32 v221, v221, v15, s[36:37]
    s_mov_b64 exec, s[38:39]
    ds_write_b64 v234, v[220:221] offset:1024
    s_mov_b64 exec, -1
    s_waitcnt lgkmcnt(5)
    v_mfma_f32_16x16x32_bf16 v[36:39], a[156:159], v[28:31], v[36:39]
    ds_read_b64_tr_b16 v[20:21], v6 offset:30720
    v_mfma_f32_16x16x32_bf16 v[40:43], a[156:159], v[32:35], v[40:43]
    ds_read_b64_tr_b16 v[22:23], v6 offset:30976
    v_mfma_f32_16x16x32_bf16 v[44:47], a[160:163], v[28:31], v[44:47]
    ds_read_b64_tr_b16 v[24:25], v7 offset:30720
    v_mfma_f32_16x16x32_bf16 v[48:51], a[160:163], v[32:35], v[48:51]
    ds_read_b64_tr_b16 v[26:27], v7 offset:30976
    v_mfma_f32_16x16x32_bf16 v[52:55], a[164:167], v[28:31], v[52:55]
    buffer_load_dwordx4 a[96:99], v1, s[8:11], s57 offen offset:0 sc1
    v_mfma_f32_16x16x32_bf16 v[56:59], a[164:167], v[32:35], v[56:59]
    buffer_load_dwordx4 a[100:103], v1, s[8:11], s57 offen offset:1024 sc1
    s_waitcnt lgkmcnt(4)
    s_barrier
    ds_read_b64 v[226:227], v235 offset:1024
    ds_read_b64 v[228:229], v235 offset:1280
    ds_read_b64 v[230:231], v222 offset:1024
    ds_read_b64 v[232:233], v222 offset:1280
    v_mfma_f32_16x16x32_bf16 v[36:39], a[168:171], v[240:243], v[36:39]
    ds_read_b64_tr_b16 v[28:29], v6 offset:32768
    v_mfma_f32_16x16x32_bf16 v[40:43], a[168:171], v[244:247], v[40:43]
    ds_read_b64_tr_b16 v[30:31], v6 offset:33024
    v_mfma_f32_16x16x32_bf16 v[44:47], a[172:175], v[240:243], v[44:47]
    ds_read_b64_tr_b16 v[32:33], v7 offset:32768
    v_mfma_f32_16x16x32_bf16 v[48:51], a[172:175], v[244:247], v[48:51]
    ds_read_b64_tr_b16 v[34:35], v7 offset:33024
    v_mfma_f32_16x16x32_bf16 v[52:55], a[176:179], v[240:243], v[52:55]
    buffer_load_dwordx4 a[104:107], v1, s[8:11], s57 offen offset:2048 sc1
    v_mfma_f32_16x16x32_bf16 v[56:59], a[176:179], v[244:247], v[56:59]
    buffer_load_dwordx4 a[108:111], v1, s[8:11], s57 offen offset:3072 sc1
    s_add_u32 s57, s57, 4096
    s_waitcnt vmcnt(4)
    s_bfm_b64 exec, 8, 0
    v_cmp_ne_u32 vcc, s12, v61
    s_mov_b64 exec, -1
    s_cbranch_vccz L_f_pok_46
    s_mov_b32 s13, 40000
L_f_pspin_47:
    s_bfm_b64 exec, 8, 0
    buffer_load_dword v61, v60, s[8:11], s94 offen sc0 sc1
    s_waitcnt vmcnt(0)
    v_cmp_ne_u32 vcc, s12, v61
    s_mov_b64 exec, -1
    s_cbranch_vccz L_f_pok_46
    s_sub_u32 s13, s13, 1
    s_cmp_eq_u32 s13, 0
    s_cbranch_scc1 L_bail
    s_branch L_f_pspin_47
L_f_pok_46:
    s_lshl_b32 s66, s4, 1
    s_add_u32 s66, s66, 0
    s_mul_i32 s66, s66, 48
    s_mul_i32 s67, s3, 12
    s_add_u32 s66, s66, s67
    s_lshl_b32 s66, s66, 10
    s_add_u32 s95, s66, 16777216
    s_waitcnt lgkmcnt(8)
    v_mfma_f32_16x16x32_bf16 v[36:39], a[180:183], v[20:23], v[36:39]
    ds_read_b64_tr_b16 v[240:241], v6 offset:34816
    v_mfma_f32_16x16x32_bf16 v[40:43], a[180:183], v[24:27], v[40:43]
    ds_read_b64_tr_b16 v[242:243], v6 offset:35072
    v_mfma_f32_16x16x32_bf16 v[44:47], a[184:187], v[20:23], v[44:47]
    ds_read_b64_tr_b16 v[244:245], v7 offset:34816
    v_mfma_f32_16x16x32_bf16 v[48:51], a[184:187], v[24:27], v[48:51]
    ds_read_b64_tr_b16 v[246:247], v7 offset:35072
    v_mfma_f32_16x16x32_bf16 v[52:55], a[188:191], v[20:23], v[52:55]
    buffer_load_dwordx4 v[64:67], v1, s[8:11], s95 offen offset:0 sc1
    v_mfma_f32_16x16x32_bf16 v[56:59], a[188:191], v[24:27], v[56:59]
    buffer_load_dwordx4 v[68:71], v251, s[8:11], s95 offen offset:0 sc1
    s_waitcnt lgkmcnt(8)
    v_add_f32 v226, v226, v228
    v_add_f32 v230, v230, v232
    v_add_f32 v227, v227, v229
    v_add_f32 v231, v231, v233
    v_mul_f32 v226, 0x3acccccd, v226
    v_mul_f32 v230, 0x3acccccd, v230
    v_mul_f32 v227, 0x3acccccd, v227
    s_waitcnt lgkmcnt(4)
    v_mfma_f32_16x16x32_bf16 v[36:39], a[192:195], v[28:31], v[36:39]
    ds_read_b64_tr_b16 v[20:21], v6 offset:36864
    v_mfma_f32_16x16x32_bf16 v[40:43], a[192:195], v[32:35], v[40:43]
    ds_read_b64_tr_b16 v[22:23], v6 offset:37120
    v_mfma_f32_16x16x32_bf16 v[44:47], a[196:199], v[28:31], v[44:47]
    ds_read_b64_tr_b16 v[24:25], v7 offset:36864
    v_mfma_f32_16x16x32_bf16 v[48:51], a[196:199], v[32:35], v[48:51]
    ds_read_b64_tr_b16 v[26:27], v7 offset:37120
    v_mfma_f32_16x16x32_bf16 v[52:55], a[200:203], v[28:31], v[52:55]
    buffer_load_dwordx4 v[72:75], v1, s[8:11], s95 offen offset:1024 sc1
    v_mfma_f32_16x16x32_bf16 v[56:59], a[200:203], v[32:35], v[56:59]
    buffer_load_dwordx4 v[76:79], v251, s[8:11], s95 offen offset:1024 sc1
    v_mul_f32 v231, 0x3acccccd, v231
    v_fma_f32 v227, -v226, v226, v227
    v_fma_f32 v231, -v230, v230, v231
    v_max_f32 v227, 0, v227
    v_max_f32 v231, 0, v231
    v_cvt_pk_bf16_f32 v226, v226, v227
    v_cvt_pk_bf16_f32 v230, v230, v231
    v_and_b32 v227, 0xffff0000, v226
    s_waitcnt lgkmcnt(4)
    v_mfma_f32_16x16x32_bf16 v[36:39], a[204:207], v[240:243], v[36:39]
    ds_read_b64_tr_b16 v[28:29], v6 offset:38912
    v_mfma_f32_16x16x32_bf16 v[40:43], a[204:207], v[244:247], v[40:43]
    ds_read_b64_tr_b16 v[30:31], v6 offset:39168
    v_mfma_f32_16x16x32_bf16 v[44:47], a[208:211], v[240:243], v[44:47]
    ds_read_b64_tr_b16 v[32:33], v7 offset:38912
    v_mfma_f32_16x16x32_bf16 v[48:51], a[208:211], v[244:247], v[48:51]
    ds_read_b64_tr_b16 v[34:35], v7 offset:39168
    v_mfma_f32_16x16x32_bf16 v[52:55], a[212:215], v[240:243], v[52:55]
    buffer_load_dwordx4 v[80:83], v1, s[8:11], s95 offen offset:2048 sc1
    v_mfma_f32_16x16x32_bf16 v[56:59], a[212:215], v[244:247], v[56:59]
    buffer_load_dwordx4 v[84:87], v251, s[8:11], s95 offen offset:2048 sc1
    v_and_b32 v231, 0xffff0000, v230
    v_lshlrev_b32 v226, 16, v226
    v_lshlrev_b32 v230, 16, v230
    v_add_f32 v227, 0x3727c5ac, v227
    v_add_f32 v231, 0x3727c5ac, v231
    v_cvt_pk_bf16_f32 v227, v227, v227
    v_cvt_pk_bf16_f32 v231, v231, v231
    v_and_b32 v227, 0xffff0000, v227
    s_waitcnt lgkmcnt(4)
    v_mfma_f32_16x16x32_bf16 v[36:39], a[216:219], v[20:23], v[36:39]
    buffer_load_dwordx4 v[88:91], v1, s[8:11], s95 offen offset:3072 sc1
    v_mfma_f32_16x16x32_bf16 v[40:43], a[216:219], v[24:27], v[40:43]
    buffer_load_dwordx4 v[92:95], v251, s[8:11], s95 offen offset:3072 sc1
    s_add_u32 s95, s95, 4096
    v_mfma_f32_16x16x32_bf16 v[44:47], a[220:223], v[20:23], v[44:47]
    v_and_b32 v231, 0xffff0000, v231
    v_mfma_f32_16x16x32_bf16 v[48:51], a[220:223], v[24:27], v[48:51]
    v_sqrt_f32 v227, v227
    v_mfma_f32_16x16x32_bf16 v[52:55], a[224:227], v[20:23], v[52:55]
    v_sqrt_f32 v231, v231
    v_mfma_f32_16x16x32_bf16 v[56:59], a[224:227], v[24:27], v[56:59]
    s_nop 0
    v_cvt_pk_bf16_f32 v227, v227, v227
    v_cvt_pk_bf16_f32 v231, v231, v231
    v_and_b32 v227, 0xffff0000, v227
    v_and_b32 v231, 0xffff0000, v231
    s_waitcnt lgkmcnt(0)
    v_mfma_f32_16x16x32_bf16 v[36:39], a[228:231], v[28:31], v[36:39]
    buffer_load_dwordx4 v[96:99], v1, s[8:11], s95 offen offset:0 sc1
    v_mfma_f32_16x16x32_bf16 v[40:43], a[228:231], v[32:35], v[40:43]
    buffer_load_dwordx4 v[100:103], v251, s[8:11], s95 offen offset:0 sc1
    v_mfma_f32_16x16x32_bf16 v[44:47], a[232:235], v[28:31], v[44:47]
    v_rcp_f32 v144, v227
    v_mfma_f32_16x16x32_bf16 v[48:51], a[232:235], v[32:35], v[48:51]
    v_rcp_f32 v146, v231
    v_mfma_f32_16x16x32_bf16 v[52:55], a[236:239], v[28:31], v[52:55]
    s_nop 0
    v_mfma_f32_16x16x32_bf16 v[56:59], a[236:239], v[32:35], v[56:59]
    v_mul_f32 v148, v226, v144
    v_mul_f32 v150, v230, v146
    v_sub_f32 v148, 0, v148
    v_sub_f32 v150, 0, v150
    v_pk_fma_f32 v[20:21], v[112:113], v[148:149], v[130:131] op_sel_hi:[1,0,1]
    v_pk_fma_f32 v[22:23], v[114:115], v[148:149], v[132:133] op_sel_hi:[1,0,1]
    v_pk_fma_f32 v[36:37], v[36:37], v[144:145], v[20:21] op_sel_hi:[1,0,1]
    v_pk_fma_f32 v[38:39], v[38:39], v[144:145], v[22:23] op_sel_hi:[1,0,1]
    v_pk_mul_f32 v[20:21], v[36:37], v[36:37]
    v_pk_mul_f32 v[22:23], v[38:39], v[38:39]
    buffer_load_dwordx4 v[104:107], v1, s[8:11], s95 offen offset:1024 sc1
    v_pk_fma_f32 v[20:21], v[20:21], s[72:73], v[152:153]
    v_pk_fma_f32 v[22:23], v[22:23], s[72:73], v[152:153]
    v_pk_mul_f32 v[20:21], v[20:21], v[36:37]
    v_pk_mul_f32 v[22:23], v[22:23], v[38:39]
    v_exp_f32 v20, v20
    v_exp_f32 v21, v21
    v_exp_f32 v22, v22
    v_exp_f32 v23, v23
    buffer_load_dwordx4 a[112:115], v1, s[8:11], s57 offen offset:0 sc1
    v_pk_add_f32 v[20:21], v[20:21], v[154:155]
    v_pk_add_f32 v[22:23], v[22:23], v[154:155]
    v_rcp_f32 v20, v20
    v_rcp_f32 v21, v21
    v_rcp_f32 v22, v22
    v_rcp_f32 v23, v23
    buffer_load_dwordx4 v[108:111], v251, s[8:11], s95 offen offset:1024 sc1
    v_pk_mul_f32 v[20:21], v[20:21], v[36:37]
    v_pk_mul_f32 v[22:23], v[22:23], v[38:39]
    v_cvt_pk_bf16_f32 v156, v20, v21
    v_cvt_pk_bf16_f32 v157, v22, v23
    v_pk_fma_f32 v[20:21], v[116:117], v[148:149], v[134:135] op_sel_hi:[1,0,1]
    v_pk_fma_f32 v[22:23], v[118:119], v[148:149], v[136:137] op_sel_hi:[1,0,1]
    v_pk_fma_f32 v[44:45], v[44:45], v[144:145], v[20:21] op_sel_hi:[1,0,1]
    v_pk_fma_f32 v[46:47], v[46:47], v[144:145], v[22:23] op_sel_hi:[1,0,1]
    v_pk_mul_f32 v[20:21], v[44:45], v[44:45]
    v_pk_mul_f32 v[22:23], v[46:47], v[46:47]
    buffer_load_dwordx4 a[116:119], v1, s[8:11], s57 offen offset:1024 sc1
    v_pk_fma_f32 v[20:21], v[20:21], s[72:73], v[152:153]
    v_pk_fma_f32 v[22:23], v[22:23], s[72:73], v[152:153]
    v_pk_mul_f32 v[20:21], v[20:21], v[44:45]
    v_pk_mul_f32 v[22:23], v[22:23], v[46:47]
    v_exp_f32 v20, v20
    v_exp_f32 v21, v21
    v_exp_f32 v22, v22
    v_exp_f32 v23, v23
    buffer_load_dwordx4 v[172:175], v1, s[8:11], s95 offen offset:2048 sc1
    v_pk_add_f32 v[20:21], v[20:21], v[154:155]
    v_pk_add_f32 v[22:23], v[22:23], v[154:155]
    v_rcp_f32 v20, v20
    v_rcp_f32 v21, v21
    v_rcp_f32 v22, v22
    v_rcp_f32 v23, v23
    buffer_load_dwordx4 a[120:123], v1, s[8:11], s57 offen offset:2048 sc1
    v_pk_mul_f32 v[20:21], v[20:21], v[44:45]
    v_pk_mul_f32 v[22:23], v[22:23], v[46:47]
    v_cvt_pk_bf16_f32 v158, v20, v21
    v_cvt_pk_bf16_f32 v159, v22, v23
    v_pk_fma_f32 v[20:21], v[120:121], v[148:149], v[138:139] op_sel_hi:[1,0,1]
    v_pk_fma_f32 v[22:23], v[122:123], v[148:149], v[140:141] op_sel_hi:[1,0,1]
    v_pk_fma_f32 v[52:53], v[52:53], v[144:145], v[20:21] op_sel_hi:[1,0,1]
    v_pk_fma_f32 v[54:55], v[54:55], v[144:145], v[22:23] op_sel_hi:[1,0,1]
    v_pk_mul_f32 v[20:21], v[52:53], v[52:53]
    v_pk_mul_f32 v[22:23], v[54:55], v[54:55]
    buffer_load_dwordx4 v[176:179], v251, s[8:11], s95 offen offset:2048 sc1
    v_pk_fma_f32 v[20:21], v[20:21], s[72:73], v[152:153]
    v_pk_fma_f32 v[22:23], v[22:23], s[72:73], v[152:153]
    v_pk_mul_f32 v[20:21], v[20:21], v[52:53]
    v_pk_mul_f32 v[22:23], v[22:23], v[54:55]
    v_exp_f32 v20, v20
    v_exp_f32 v21, v21
    v_exp_f32 v22, v22
    v_exp_f32 v23, v23
    buffer_load_dwordx4 a[124:127], v1, s[8:11], s57 offen offset:3072 sc1
    s_add_u32 s57, s57, 4096
    v_pk_add_f32 v[20:21], v[20:21], v[154:155]
    v_pk_add_f32 v[22:23], v[22:23], v[154:155]
    v_rcp_f32 v20, v20
    v_rcp_f32 v21, v21
    v_rcp_f32 v22, v22
    v_rcp_f32 v23, v23
    buffer_load_dwordx4 v[180:183], v1, s[8:11], s95 offen offset:3072 sc1
    v_pk_mul_f32 v[20:21], v[20:21], v[52:53]
    v_pk_mul_f32 v[22:23], v[22:23], v[54:55]
    v_cvt_pk_bf16_f32 v160, v20, v21
    v_cvt_pk_bf16_f32 v161, v22, v23
    buffer_store_dwordx4 v[156:159], v1, s[8:11], s52 offen sc0 sc1
    buffer_store_dwordx2 v[160:161], v142, s[8:11], s53 offen sc0 sc1
    v_pk_fma_f32 v[20:21], v[112:113], v[150:151], v[130:131] op_sel_hi:[1,0,1]
    v_pk_fma_f32 v[22:23], v[114:115], v[150:151], v[132:133] op_sel_hi:[1,0,1]
    v_pk_fma_f32 v[40:41], v[40:41], v[146:147], v[20:21] op_sel_hi:[1,0,1]
    v_pk_fma_f32 v[42:43], v[42:43], v[146:147], v[22:23] op_sel_hi:[1,0,1]
    v_pk_mul_f32 v[20:21], v[40:41], v[40:41]
    v_pk_mul_f32 v[22:23], v[42:43], v[42:43]
    buffer_load_dwordx4 a[128:131], v1, s[8:11], s57 offen offset:0 sc1
    v_pk_fma_f32 v[20:21], v[20:21], s[72:73], v[152:153]
    v_pk_fma_f32 v[22:23], v[22:23], s[72:73], v[152:153]
    v_pk_mul_f32 v[20:21], v[20:21], v[40:41]
    v_pk_mul_f32 v[22:23], v[22:23], v[42:43]
    v_exp_f32 v20, v20
    v_exp_f32 v21, v21
    v_exp_f32 v22, v22
    v_exp_f32 v23, v23
    buffer_load_dwordx4 v[184:187], v251, s[8:11], s95 offen offset:3072 sc1
    s_add_u32 s95, s95, 4096
    v_pk_add_f32 v[20:21], v[20:21], v[154:155]
    v_pk_add_f32 v[22:23], v[22:23], v[154:155]
    v_rcp_f32 v20, v20
    v_rcp_f32 v21, v21
    v_rcp_f32 v22, v22
    v_rcp_f32 v23, v23
    buffer_load_dwordx4 a[132:135], v1, s[8:11], s57 offen offset:1024 sc1
    v_pk_mul_f32 v[20:21], v[20:21], v[40:41]
    v_pk_mul_f32 v[22:23], v[22:23], v[42:43]
    v_cvt_pk_bf16_f32 v164, v20, v21
    v_cvt_pk_bf16_f32 v165, v22, v23
    v_pk_fma_f32 v[20:21], v[116:117], v[150:151], v[134:135] op_sel_hi:[1,0,1]
    v_pk_fma_f32 v[22:23], v[118:119], v[150:151], v[136:137] op_sel_hi:[1,0,1]
    v_pk_fma_f32 v[48:49], v[48:49], v[146:147], v[20:21] op_sel_hi:[1,0,1]
    v_pk_fma_f32 v[50:51], v[50:51], v[146:147], v[22:23] op_sel_hi:[1,0,1]
    v_pk_mul_f32 v[20:21], v[48:49], v[48:49]
    v_pk_mul_f32 v[22:23], v[50:51], v[50:51]
    buffer_load_dwordx4 v[188:191], v1, s[8:11], s95 offen offset:0 sc1
    v_pk_fma_f32 v[20:21], v[20:21], s[72:73], v[152:153]
    v_pk_fma_f32 v[22:23], v[22:23], s[72:73], v[152:153]
    v_pk_mul_f32 v[20:21], v[20:21], v[48:49]
    v_pk_mul_f32 v[22:23], v[22:23], v[50:51]
    v_exp_f32 v20, v20
    v_exp_f32 v21, v21
    v_exp_f32 v22, v22
    v_exp_f32 v23, v23
    buffer_load_dwordx4 a[136:139], v1, s[8:11], s57 offen offset:2048 sc1
    v_pk_add_f32 v[20:21], v[20:21], v[154:155]
    v_pk_add_f32 v[22:23], v[22:23], v[154:155]
    v_rcp_f32 v20, v20
    v_rcp_f32 v21, v21
    v_rcp_f32 v22, v22
    v_rcp_f32 v23, v23
    buffer_load_dwordx4 v[192:195], v251, s[8:11], s95 offen offset:0 sc1
    v_pk_mul_f32 v[20:21], v[20:21], v[48:49]
    v_pk_mul_f32 v[22:23], v[22:23], v[50:51]
    v_cvt_pk_bf16_f32 v166, v20, v21
    v_cvt_pk_bf16_f32 v167, v22, v23
    v_pk_fma_f32 v[20:21], v[120:121], v[150:151], v[138:139] op_sel_hi:[1,0,1]
    v_pk_fma_f32 v[22:23], v[122:123], v[150:151], v[140:141] op_sel_hi:[1,0,1]
    v_pk_fma_f32 v[56:57], v[56:57], v[146:147], v[20:21] op_sel_hi:[1,0,1]
    v_pk_fma_f32 v[58:59], v[58:59], v[146:147], v[22:23] op_sel_hi:[1,0,1]
    v_pk_mul_f32 v[20:21], v[56:57], v[56:57]
    v_pk_mul_f32 v[22:23], v[58:59], v[58:59]
    buffer_load_dwordx4 a[140:143], v1, s[8:11], s57 offen offset:3072 sc1
    s_add_u32 s57, s57, 4096
    v_pk_fma_f32 v[20:21], v[20:21], s[72:73], v[152:153]
    v_pk_fma_f32 v[22:23], v[22:23], s[72:73], v[152:153]
    v_pk_mul_f32 v[20:21], v[20:21], v[56:57]
    v_pk_mul_f32 v[22:23], v[22:23], v[58:59]
    v_exp_f32 v20, v20
    v_exp_f32 v21, v21
    v_exp_f32 v22, v22
    v_exp_f32 v23, v23
    buffer_load_dwordx4 a[144:147], v1, s[8:11], s57 offen offset:0 sc1
    v_pk_add_f32 v[20:21], v[20:21], v[154:155]
    v_pk_add_f32 v[22:23], v[22:23], v[154:155]
    v_rcp_f32 v20, v20
    v_rcp_f32 v21, v21
    v_rcp_f32 v22, v22
    v_rcp_f32 v23, v23
    buffer_load_dwordx4 a[148:151], v1, s[8:11], s57 offen offset:1024 sc1
    v_pk_mul_f32 v[20:21], v[20:21], v[56:57]
    v_pk_mul_f32 v[22:23], v[22:23], v[58:59]
    v_cvt_pk_bf16_f32 v168, v20, v21
    v_cvt_pk_bf16_f32 v169, v22, v23
    buffer_store_dwordx4 v[164:167], v1, s[8:11], s54 offen sc0 sc1
    buffer_store_dwordx2 v[168:169], v142, s[8:11], s55 offen sc0 sc1
    v_lshlrev_b32 v8, 3, v2
    buffer_load_dwordx2 v[112:113], v8, s[24:27], s42 offen offset:0
    buffer_load_dwordx2 v[114:115], v8, s[24:27], s42 offen offset:64
    buffer_load_dwordx2 v[116:117], v8, s[24:27], s42 offen offset:128
    s_waitcnt vmcnt(33)
    v_mfma_f32_16x16x32_bf16 v[20:23], a[0:3], v[64:67], 0
    buffer_load_dwordx4 a[152:155], v1, s[8:11], s57 offen offset:2048 sc1
    v_mfma_f32_16x16x32_bf16 v[24:27], a[0:3], v[68:71], 0
    v_mfma_f32_16x16x32_bf16 v[28:31], a[4:7], v[64:67], 0
    buffer_load_dwordx4 a[156:159], v1, s[8:11], s57 offen offset:3072 sc1
    s_add_u32 s57, s57, 4096
    v_mfma_f32_16x16x32_bf16 v[32:35], a[4:7], v[68:71], 0
    v_mfma_f32_16x16x32_bf16 v[36:39], a[8:11], v[64:67], 0
    v_mfma_f32_16x16x32_bf16 v[40:43], a[8:11], v[68:71], 0
    v_mfma_f32_16x16x32_bf16 v[44:47], a[12:15], v[64:67], 0
    v_mfma_f32_16x16x32_bf16 v[48:51], a[12:15], v[68:71], 0
    v_mfma_f32_16x16x32_bf16 v[52:55], a[16:19], v[64:67], 0
    v_mfma_f32_16x16x32_bf16 v[56:59], a[16:19], v[68:71], 0
    s_waitcnt vmcnt(33)
    v_mfma_f32_16x16x32_bf16 v[20:23], a[20:23], v[72:75], v[20:23]
    buffer_load_dwordx4 a[160:163], v1, s[8:11], s57 offen offset:0 sc1
    v_mfma_f32_16x16x32_bf16 v[24:27], a[20:23], v[76:79], v[24:27]
    v_mfma_f32_16x16x32_bf16 v[28:31], a[24:27], v[72:75], v[28:31]
    buffer_load_dwordx4 a[164:167], v1, s[8:11], s57 offen offset:1024 sc1
    v_mfma_f32_16x16x32_bf16 v[32:35], a[24:27], v[76:79], v[32:35]
    v_mfma_f32_16x16x32_bf16 v[36:39], a[28:31], v[72:75], v[36:39]
    v_mfma_f32_16x16x32_bf16 v[40:43], a[28:31], v[76:79], v[40:43]
    v_mfma_f32_16x16x32_bf16 v[44:47], a[32:35], v[72:75], v[44:47]
    v_mfma_f32_16x16x32_bf16 v[48:51], a[32:35], v[76:79], v[48:51]
    v_mfma_f32_16x16x32_bf16 v[52:55], a[36:39], v[72:75], v[52:55]
    v_mfma_f32_16x16x32_bf16 v[56:59], a[36:39], v[76:79], v[56:59]
    s_waitcnt vmcnt(33)
    v_mfma_f32_16x16x32_bf16 v[20:23], a[40:43], v[80:83], v[20:23]
    buffer_load_dwordx4 a[168:171], v1, s[8:11], s57 offen offset:2048 sc1
    v_mfma_f32_16x16x32_bf16 v[24:27], a[40:43], v[84:87], v[24:27]
    v_mfma_f32_16x16x32_bf16 v[28:31], a[44:47], v[80:83], v[28:31]
    buffer_load_dwordx4 a[172:175], v1, s[8:11], s57 offen offset:3072 sc1
    s_add_u32 s57, s57, 4096
    v_mfma_f32_16x16x32_bf16 v[32:35], a[44:47], v[84:87], v[32:35]
    v_mfma_f32_16x16x32_bf16 v[36:39], a[48:51], v[80:83], v[36:39]
    v_mfma_f32_16x16x32_bf16 v[40:43], a[48:51], v[84:87], v[40:43]
    v_mfma_f32_16x16x32_bf16 v[44:47], a[52:55], v[80:83], v[44:47]
    v_mfma_f32_16x16x32_bf16 v[48:51], a[52:55], v[84:87], v[48:51]
    v_mfma_f32_16x16x32_bf16 v[52:55], a[56:59], v[80:83], v[52:55]
    v_mfma_f32_16x16x32_bf16 v[56:59], a[56:59], v[84:87], v[56:59]
    s_waitcnt vmcnt(33)
    v_mfma_f32_16x16x32_bf16 v[20:23], a[60:63], v[88:91], v[20:23]
    buffer_load_dwordx4 a[176:179], v1, s[8:11], s57 offen offset:0 sc1
    v_mfma_f32_16x16x32_bf16 v[24:27], a[60:63], v[92:95], v[24:27]
    v_mfma_f32_16x16x32_bf16 v[28:31], a[64:67], v[88:91], v[28:31]
    buffer_load_dwordx4 v[196:199], v1, s[8:11], s95 offen offset:1024 sc1
    v_mfma_f32_16x16x32_bf16 v[32:35], a[64:67], v[92:95], v[32:35]
    v_mfma_f32_16x16x32_bf16 v[36:39], a[68:71], v[88:91], v[36:39]
    v_mfma_f32_16x16x32_bf16 v[40:43], a[68:71], v[92:95], v[40:43]
    v_mfma_f32_16x16x32_bf16 v[44:47], a[72:75], v[88:91], v[44:47]
    v_mfma_f32_16x16x32_bf16 v[48:51], a[72:75], v[92:95], v[48:51]
    v_mfma_f32_16x16x32_bf16 v[52:55], a[76:79], v[88:91], v[52:55]
    v_mfma_f32_16x16x32_bf16 v[56:59], a[76:79], v[92:95], v[56:59]
    s_waitcnt vmcnt(11)
    s_barrier
    s_lshl_b32 s66, s2, 6
    s_add_u32 s66, s66, 24248320
    s_cmp_lg_u32 s3, 0
    s_cbranch_scc1 L_f_flag_48
    s_mov_b64 exec, 1
    v_mov_b32 v252, s12
    v_mov_b32 v253, 0
    buffer_store_dword v252, v253, s[8:11], s66 offen sc0 sc1
    s_mov_b64 exec, -1
L_f_flag_48:
    v_mfma_f32_16x16x32_bf16 v[20:23], a[80:83], v[96:99], v[20:23]
    buffer_load_dwordx4 v[200:203], v251, s[8:11], s95 offen offset:1024 sc1
    v_mfma_f32_16x16x32_bf16 v[24:27], a[80:83], v[100:103], v[24:27]
    v_mfma_f32_16x16x32_bf16 v[28:31], a[84:87], v[96:99], v[28:31]
    buffer_load_dwordx4 v[204:207], v1, s[8:11], s95 offen offset:2048 sc1
    v_mfma_f32_16x16x32_bf16 v[32:35], a[84:87], v[100:103], v[32:35]
    v_mfma_f32_16x16x32_bf16 v[36:39], a[88:91], v[96:99], v[36:39]
    v_mfma_f32_16x16x32_bf16 v[40:43], a[88:91], v[100:103], v[40:43]
    v_mfma_f32_16x16x32_bf16 v[44:47], a[92:95], v[96:99], v[44:47]
    v_mfma_f32_16x16x32_bf16 v[48:51], a[92:95], v[100:103], v[48:51]
    v_mfma_f32_16x16x32_bf16 v[52:55], a[96:99], v[96:99], v[52:55]
    v_mfma_f32_16x16x32_bf16 v[56:59], a[96:99], v[100:103], v[56:59]
    v_mfma_f32_16x16x32_bf16 v[20:23], a[100:103], v[104:107], v[20:23]
    buffer_load_dwordx4 v[208:211], v251, s[8:11], s95 offen offset:2048 sc1
    v_mfma_f32_16x16x32_bf16 v[24:27], a[100:103], v[108:111], v[24:27]
    v_mfma_f32_16x16x32_bf16 v[28:31], a[104:107], v[104:107], v[28:31]
    buffer_load_dwordx4 v[212:215], v1, s[8:11], s95 offen offset:3072 sc1
    v_mfma_f32_16x16x32_bf16 v[32:35], a[104:107], v[108:111], v[32:35]
    v_mfma_f32_16x16x32_bf16 v[36:39], a[108:111], v[104:107], v[36:39]
    v_mfma_f32_16x16x32_bf16 v[40:43], a[108:111], v[108:111], v[40:43]
    v_mfma_f32_16x16x32_bf16 v[44:47], a[112:115], v[104:107], v[44:47]
    v_mfma_f32_16x16x32_bf16 v[48:51], a[112:115], v[108:111], v[48:51]
    v_mfma_f32_16x16x32_bf16 v[52:55], a[116:119], v[104:107], v[52:55]
    v_mfma_f32_16x16x32_bf16 v[56:59], a[116:119], v[108:111], v[56:59]
    v_mfma_f32_16x16x32_bf16 v[20:23], a[120:123], v[172:175], v[20:23]
    buffer_load_dwordx4 v[216:219], v251, s[8:11], s95 offen offset:3072 sc1
    s_add_u32 s95, s95, 4096
    v_mfma_f32_16x16x32_bf16 v[24:27], a[120:123], v[176:179], v[24:27]
    v_mfma_f32_16x16x32_bf16 v[28:31], a[124:127], v[172:175], v[28:31]
    v_mfma_f32_16x16x32_bf16 v[32:35], a[124:127], v[176:179], v[32:35]
    v_mfma_f32_16x16x32_bf16 v[36:39], a[128:131], v[172:175], v[36:39]
    v_mfma_f32_16x16x32_bf16 v[40:43], a[128:131], v[176:179], v[40:43]
    v_mfma_f32_16x16x32_bf16 v[44:47], a[132:135], v[172:175], v[44:47]
    v_mfma_f32_16x16x32_bf16 v[48:51], a[132:135], v[176:179], v[48:51]
    v_mfma_f32_16x16x32_bf16 v[52:55], a[136:139], v[172:175], v[52:55]
    v_mfma_f32_16x16x32_bf16 v[56:59], a[136:139], v[176:179], v[56:59]
    s_waitcnt vmcnt(11)
    v_mfma_f32_16x16x32_bf16 v[20:23], a[140:143], v[180:183], v[20:23]
    v_mfma_f32_16x16x32_bf16 v[24:27], a[140:143], v[184:187], v[24:27]
    v_mfma_f32_16x16x32_bf16 v[28:31], a[144:147], v[180:183], v[28:31]
    v_mfma_f32_16x16x32_bf16 v[32:35], a[144:147], v[184:187], v[32:35]
    v_mfma_f32_16x16x32_bf16 v[36:39], a[148:151], v[180:183], v[36:39]
    v_mfma_f32_16x16x32_bf16 v[40:43], a[148:151], v[184:187], v[40:43]
    v_mfma_f32_16x16x32_bf16 v[44:47], a[152:155], v[180:183], v[44:47]
    v_mfma_f32_16x16x32_bf16 v[48:51], a[152:155], v[184:187], v[48:51]
    v_mfma_f32_16x16x32_bf16 v[52:55], a[156:159], v[180:183], v[52:55]
    v_mfma_f32_16x16x32_bf16 v[56:59], a[156:159], v[184:187], v[56:59]
    s_waitcnt vmcnt(6)
    v_mfma_f32_16x16x32_bf16 v[20:23], a[160:163], v[188:191], v[20:23]
    v_add_u32 v9, s51, v1
    v_mfma_f32_16x16x32_bf16 v[24:27], a[160:163], v[192:195], v[24:27]
    v_mfma_f32_16x16x32_bf16 v[28:31], a[164:167], v[188:191], v[28:31]
    ds_read_b128 v[140:143], v9 offset:0
    v_mfma_f32_16x16x32_bf16 v[32:35], a[164:167], v[192:195], v[32:35]
    v_mfma_f32_16x16x32_bf16 v[36:39], a[168:171], v[188:191], v[36:39]
    ds_read_b128 v[144:147], v9 offset:1024
    v_mfma_f32_16x16x32_bf16 v[40:43], a[168:171], v[192:195], v[40:43]
    v_mfma_f32_16x16x32_bf16 v[44:47], a[172:175], v[188:191], v[44:47]
    ds_read_b128 v[148:151], v9 offset:2048
    v_mfma_f32_16x16x32_bf16 v[48:51], a[172:175], v[192:195], v[48:51]
    v_mfma_f32_16x16x32_bf16 v[52:55], a[176:179], v[188:191], v[52:55]
    ds_read_b128 v[152:155], v9 offset:3072
    v_mfma_f32_16x16x32_bf16 v[56:59], a[176:179], v[192:195], v[56:59]
    ds_read_b128 v[156:159], v9 offset:4096
    s_waitcnt vmcnt(4)
    s_waitcnt lgkmcnt(0)
    v_mfma_f32_16x16x32_bf16 v[20:23], v[140:143], v[196:199], v[20:23]
    ds_read_b128 v[120:123], v9 offset:5120
    v_mfma_f32_16x16x32_bf16 v[24:27], v[140:143], v[200:203], v[24:27]
    v_mfma_f32_16x16x32_bf16 v[28:31], v[144:147], v[196:199], v[28:31]
    ds_read_b128 v[124:127], v9 offset:6144
    v_mfma_f32_16x16x32_bf16 v[32:35], v[144:147], v[200:203], v[32:35]
    v_mfma_f32_16x16x32_bf16 v[36:39], v[148:151], v[196:199], v[36:39]
    ds_read_b128 v[128:131], v9 offset:7168
    v_mfma_f32_16x16x32_bf16 v[40:43], v[148:151], v[200:203], v[40:43]
    v_mfma_f32_16x16x32_bf16 v[44:47], v[152:155], v[196:199], v[44:47]
    ds_read_b128 v[132:135], v9 offset:8192
    v_mfma_f32_16x16x32_bf16 v[48:51], v[152:155], v[200:203], v[48:51]
    v_mfma_f32_16x16x32_bf16 v[52:55], v[156:159], v[196:199], v[52:55]
    ds_read_b128 v[136:139], v9 offset:9216
    v_mfma_f32_16x16x32_bf16 v[56:59], v[156:159], v[200:203], v[56:59]
    s_waitcnt vmcnt(2)
    s_waitcnt lgkmcnt(0)
    v_mfma_f32_16x16x32_bf16 v[20:23], v[120:123], v[204:207], v[20:23]
    ds_read_b128 v[140:143], v9 offset:10240
    v_mfma_f32_16x16x32_bf16 v[24:27], v[120:123], v[208:211], v[24:27]
    v_mfma_f32_16x16x32_bf16 v[28:31], v[124:127], v[204:207], v[28:31]
    ds_read_b128 v[144:147], v9 offset:11264
    v_mfma_f32_16x16x32_bf16 v[32:35], v[124:127], v[208:211], v[32:35]
    v_mfma_f32_16x16x32_bf16 v[36:39], v[128:131], v[204:207], v[36:39]
    ds_read_b128 v[148:151], v9 offset:12288
    v_mfma_f32_16x16x32_bf16 v[40:43], v[128:131], v[208:211], v[40:43]
    v_mfma_f32_16x16x32_bf16 v[44:47], v[132:135], v[204:207], v[44:47]
    ds_read_b128 v[152:155], v9 offset:13312
    v_mfma_f32_16x16x32_bf16 v[48:51], v[132:135], v[208:211], v[48:51]
    v_mfma_f32_16x16x32_bf16 v[52:55], v[136:139], v[204:207], v[52:55]
    ds_read_b128 v[156:159], v9 offset:14336
    v_mfma_f32_16x16x32_bf16 v[56:59], v[136:139], v[208:211], v[56:59]
    s_mov_b32 s94, 24248320
    s_bfm_b64 exec, 8, 0
    buffer_load_dword v61, v60, s[8:11], s94 offen sc0 sc1
    s_mov_b64 exec, -1
    s_waitcnt vmcnt(1)
    s_waitcnt lgkmcnt(0)
    v_mfma_f32_16x16x32_bf16 v[20:23], v[140:143], v[212:215], v[20:23]
    v_mfma_f32_16x16x32_bf16 v[24:27], v[140:143], v[216:219], v[24:27]
    v_mfma_f32_16x16x32_bf16 v[28:31], v[144:147], v[212:215], v[28:31]
    v_mfma_f32_16x16x32_bf16 v[32:35], v[144:147], v[216:219], v[32:35]
    v_mfma_f32_16x16x32_bf16 v[36:39], v[148:151], v[212:215], v[36:39]
    v_mfma_f32_16x16x32_bf16 v[40:43], v[148:151], v[216:219], v[40:43]
    v_mfma_f32_16x16x32_bf16 v[44:47], v[152:155], v[212:215], v[44:47]
    v_mfma_f32_16x16x32_bf16 v[48:51], v[152:155], v[216:219], v[48:51]
    v_mfma_f32_16x16x32_bf16 v[52:55], v[156:159], v[212:215], v[52:55]
    v_mfma_f32_16x16x32_bf16 v[56:59], v[156:159], v[216:219], v[56:59]
    s_waitcnt vmcnt(0)
    s_bfm_b64 exec, 8, 0
    v_cmp_ne_u32 vcc, s12, v61
    s_mov_b64 exec, -1
    s_cbranch_vccz L_f_pok_49
    s_mov_b32 s13, 40000
L_f_pspin_50:
    s_bfm_b64 exec, 8, 0
    buffer_load_dword v61, v60, s[8:11], s94 offen sc0 sc1
    s_waitcnt vmcnt(0)
    v_cmp_ne_u32 vcc, s12, v61
    s_mov_b64 exec, -1
    s_cbranch_vccz L_f_pok_49
    s_sub_u32 s13, s13, 1
    s_cmp_eq_u32 s13, 0
    s_cbranch_scc1 L_bail
    s_branch L_f_pspin_50
L_f_pok_49:
    s_lshl_b32 s66, s4, 1
    s_add_u32 s66, s66, 64
    s_mul_i32 s66, s66, 48
    s_mul_i32 s67, s3, 12
    s_add_u32 s66, s66, s67
    s_lshl_b32 s66, s66, 10
    s_add_u32 s95, s66, 16777216
    s_mul_i32 s66, s3, 9216
    v_add_u32 v4, s66, v250
    s_nop 5
    ds_write_b128 v4, v[20:23] offset:0
    buffer_load_dwordx4 v[64:67], v1, s[8:11], s95 offen offset:0 sc1
    ds_write_b128 v4, v[24:27] offset:1024
    buffer_load_dwordx4 v[68:71], v251, s[8:11], s95 offen offset:0 sc1
    ds_write_b128 v4, v[28:31] offset:2048
    buffer_load_dwordx4 v[72:75], v1, s[8:11], s95 offen offset:1024 sc1
    ds_write_b128 v4, v[32:35] offset:3072
    buffer_load_dwordx4 v[76:79], v251, s[8:11], s95 offen offset:1024 sc1
    ds_write_b128 v4, v[36:39] offset:4096
    buffer_load_dwordx4 v[80:83], v1, s[8:11], s95 offen offset:2048 sc1
    ds_write_b128 v4, v[40:43] offset:5120
    buffer_load_dwordx4 v[84:87], v251, s[8:11], s95 offen offset:2048 sc1
    ds_write_b128 v4, v[44:47] offset:6144
    buffer_load_dwordx4 v[88:91], v1, s[8:11], s95 offen offset:3072 sc1
    ds_write_b128 v4, v[48:51] offset:7168
    buffer_load_dwordx4 v[92:95], v251, s[8:11], s95 offen offset:3072 sc1
    s_add_u32 s95, s95, 4096
    ds_write_b128 v4, v[52:55] offset:8192
    buffer_load_dwordx4 v[96:99], v1, s[8:11], s95 offen offset:0 sc1
    ds_write_b128 v4, v[56:59] offset:9216
    buffer_load_dwordx4 v[100:103], v251, s[8:11], s95 offen offset:0 sc1
    buffer_load_dwordx4 v[104:107], v1, s[8:11], s95 offen offset:1024 sc1
    buffer_load_dwordx4 v[108:111], v251, s[8:11], s95 offen offset:1024 sc1
    s_waitcnt lgkmcnt(0)
    s_barrier
    s_waitcnt vmcnt(10)
    v_mfma_f32_16x16x32_bf16 v[20:23], a[0:3], v[64:67], 0
    buffer_load_dwordx4 v[172:175], v1, s[8:11], s95 offen offset:2048 sc1
    buffer_load_dwordx4 v[176:179], v251, s[8:11], s95 offen offset:2048 sc1
    v_mfma_f32_16x16x32_bf16 v[24:27], a[0:3], v[68:71], 0
    ds_read_b128 v[120:123], v250 offset:0
    ds_read_b128 v[124:127], v250 offset:10240
    v_mfma_f32_16x16x32_bf16 v[28:31], a[4:7], v[64:67], 0
    ds_read_b128 v[128:131], v250 offset:20480
    ds_read_b128 v[132:135], v250 offset:30720
    v_mfma_f32_16x16x32_bf16 v[32:35], a[4:7], v[68:71], 0
    v_accvgpr_read_b32 v242, a240
    v_accvgpr_read_b32 v243, a241
    v_mfma_f32_16x16x32_bf16 v[36:39], a[8:11], v[64:67], 0
    ds_read_b128 v[136:139], v250 offset:4096
    v_mfma_f32_16x16x32_bf16 v[40:43], a[8:11], v[68:71], 0
    ds_read_b128 v[140:143], v250 offset:14336
    v_mfma_f32_16x16x32_bf16 v[44:47], a[12:15], v[64:67], 0
    ds_read_b128 v[144:147], v250 offset:24576
    v_mfma_f32_16x16x32_bf16 v[48:51], a[12:15], v[68:71], 0
    ds_read_b128 v[148:151], v250 offset:34816
    v_mfma_f32_16x16x32_bf16 v[52:55], a[16:19], v[64:67], 0
    v_accvgpr_read_b32 v244, a242
    v_mfma_f32_16x16x32_bf16 v[56:59], a[16:19], v[68:71], 0
    s_waitcnt vmcnt(10)
    v_mfma_f32_16x16x32_bf16 v[20:23], a[20:23], v[72:75], v[20:23]
    buffer_load_dwordx4 v[180:183], v1, s[8:11], s95 offen offset:3072 sc1
    buffer_load_dwordx4 v[184:187], v251, s[8:11], s95 offen offset:3072 sc1
    s_add_u32 s95, s95, 4096
    v_mfma_f32_16x16x32_bf16 v[24:27], a[20:23], v[76:79], v[24:27]
    v_accvgpr_read_b32 v245, a243
    ds_read_b128 v[152:155], v250 offset:8192
    v_mfma_f32_16x16x32_bf16 v[28:31], a[24:27], v[72:75], v[28:31]
    ds_read_b128 v[156:159], v250 offset:18432
    ds_read_b128 v[160:163], v250 offset:28672
    v_mfma_f32_16x16x32_bf16 v[32:35], a[24:27], v[76:79], v[32:35]
    ds_read_b128 v[164:167], v250 offset:38912
    v_accvgpr_read_b32 v246, a244
    v_mfma_f32_16x16x32_bf16 v[36:39], a[28:31], v[72:75], v[36:39]
    v_accvgpr_read_b32 v247, a245
    v_mfma_f32_16x16x32_bf16 v[40:43], a[28:31], v[76:79], v[40:43]
    v_lshlrev_b32 v224, 16, v112
    v_mfma_f32_16x16x32_bf16 v[44:47], a[32:35], v[72:75], v[44:47]
    v_and_b32 v225, 0xffff0000, v112
    v_mfma_f32_16x16x32_bf16 v[48:51], a[32:35], v[76:79], v[48:51]
    v_lshlrev_b32 v226, 16, v113
    v_mfma_f32_16x16x32_bf16 v[52:55], a[36:39], v[72:75], v[52:55]
    v_and_b32 v227, 0xffff0000, v113
    v_mfma_f32_16x16x32_bf16 v[56:59], a[36:39], v[76:79], v[56:59]
    s_waitcnt vmcnt(10)
    v_mfma_f32_16x16x32_bf16 v[20:23], a[40:43], v[80:83], v[20:23]
    buffer_load_dwordx4 v[188:191], v1, s[8:11], s95 offen offset:0 sc1
    buffer_load_dwordx4 v[192:195], v251, s[8:11], s95 offen offset:0 sc1
    v_mfma_f32_16x16x32_bf16 v[24:27], a[40:43], v[84:87], v[24:27]
    s_waitcnt lgkmcnt(8)
    v_lshlrev_b32 v220, 16, v242
    v_mfma_f32_16x16x32_bf16 v[28:31], a[44:47], v[80:83], v[28:31]
    v_and_b32 v221, 0xffff0000, v242
    v_lshlrev_b32 v222, 16, v243
    v_mfma_f32_16x16x32_bf16 v[32:35], a[44:47], v[84:87], v[32:35]
    v_and_b32 v223, 0xffff0000, v243
    v_pk_add_f32 v[120:121], v[120:121], v[124:125]
    v_mfma_f32_16x16x32_bf16 v[36:39], a[48:51], v[80:83], v[36:39]
    v_pk_add_f32 v[128:129], v[128:129], v[132:133]
    v_mfma_f32_16x16x32_bf16 v[40:43], a[48:51], v[84:87], v[40:43]
    v_pk_add_f32 v[122:123], v[122:123], v[126:127]
    v_mfma_f32_16x16x32_bf16 v[44:47], a[52:55], v[80:83], v[44:47]
    v_pk_add_f32 v[130:131], v[130:131], v[134:135]
    v_mfma_f32_16x16x32_bf16 v[48:51], a[52:55], v[84:87], v[48:51]
    v_pk_add_f32 v[220:221], v[220:221], v[224:225]
    v_mfma_f32_16x16x32_bf16 v[52:55], a[56:59], v[80:83], v[52:55]
    v_pk_add_f32 v[222:223], v[222:223], v[226:227]
    v_mfma_f32_16x16x32_bf16 v[56:59], a[56:59], v[84:87], v[56:59]
    s_waitcnt vmcnt(10)
    v_mfma_f32_16x16x32_bf16 v[20:23], a[60:63], v[88:91], v[20:23]
    buffer_load_dwordx4 v[196:199], v1, s[8:11], s95 offen offset:1024 sc1
    buffer_load_dwordx4 v[200:203], v251, s[8:11], s95 offen offset:1024 sc1
    v_mfma_f32_16x16x32_bf16 v[24:27], a[60:63], v[92:95], v[24:27]
    v_pk_add_f32 v[120:121], v[120:121], v[128:129]
    v_pk_add_f32 v[122:123], v[122:123], v[130:131]
    v_mfma_f32_16x16x32_bf16 v[28:31], a[64:67], v[88:91], v[28:31]
    v_pk_add_f32 v[220:221], v[220:221], v[120:121]
    v_pk_add_f32 v[222:223], v[222:223], v[122:123]
    v_mfma_f32_16x16x32_bf16 v[32:35], a[64:67], v[92:95], v[32:35]
    v_cvt_pk_bf16_f32 v236, v220, v221
    v_cvt_pk_bf16_f32 v237, v222, v223
    v_mfma_f32_16x16x32_bf16 v[36:39], a[68:71], v[88:91], v[36:39]
    buffer_store_dwordx2 v[236:237], v249, s[20:23], s46 offen offset:0
    v_mfma_f32_16x16x32_bf16 v[40:43], a[68:71], v[92:95], v[40:43]
    v_lshlrev_b32 v224, 16, v114
    v_mfma_f32_16x16x32_bf16 v[44:47], a[72:75], v[88:91], v[44:47]
    v_and_b32 v225, 0xffff0000, v114
    v_mfma_f32_16x16x32_bf16 v[48:51], a[72:75], v[92:95], v[48:51]
    v_lshlrev_b32 v226, 16, v115
    v_mfma_f32_16x16x32_bf16 v[52:55], a[76:79], v[88:91], v[52:55]
    v_and_b32 v227, 0xffff0000, v115
    v_mfma_f32_16x16x32_bf16 v[56:59], a[76:79], v[92:95], v[56:59]
    s_waitcnt vmcnt(11)
    v_mfma_f32_16x16x32_bf16 v[20:23], a[80:83], v[96:99], v[20:23]
    buffer_load_dwordx4 v[204:207], v1, s[8:11], s95 offen offset:2048 sc1
    buffer_load_dwordx4 v[208:211], v251, s[8:11], s95 offen offset:2048 sc1
    v_mfma_f32_16x16x32_bf16 v[24:27], a[80:83], v[100:103], v[24:27]
    s_waitcnt lgkmcnt(4)
    v_lshlrev_b32 v220, 16, v244
    v_mfma_f32_16x16x32_bf16 v[28:31], a[84:87], v[96:99], v[28:31]
    v_and_b32 v221, 0xffff0000, v244
    v_lshlrev_b32 v222, 16, v245
    v_mfma_f32_16x16x32_bf16 v[32:35], a[84:87], v[100:103], v[32:35]
    v_and_b32 v223, 0xffff0000, v245
    v_pk_add_f32 v[136:137], v[136:137], v[140:141]
    v_mfma_f32_16x16x32_bf16 v[36:39], a[88:91], v[96:99], v[36:39]
    v_pk_add_f32 v[144:145], v[144:145], v[148:149]
    v_mfma_f32_16x16x32_bf16 v[40:43], a[88:91], v[100:103], v[40:43]
    v_pk_add_f32 v[138:139], v[138:139], v[142:143]
    v_mfma_f32_16x16x32_bf16 v[44:47], a[92:95], v[96:99], v[44:47]
    v_pk_add_f32 v[146:147], v[146:147], v[150:151]
    v_mfma_f32_16x16x32_bf16 v[48:51], a[92:95], v[100:103], v[48:51]
    v_pk_add_f32 v[220:221], v[220:221], v[224:225]
    v_mfma_f32_16x16x32_bf16 v[52:55], a[96:99], v[96:99], v[52:55]
    v_pk_add_f32 v[222:223], v[222:223], v[226:227]
    v_mfma_f32_16x16x32_bf16 v[56:59], a[96:99], v[100:103], v[56:59]
    s_waitcnt vmcnt(11)
    v_mfma_f32_16x16x32_bf16 v[20:23], a[100:103], v[104:107], v[20:23]
    buffer_load_dwordx4 v[212:215], v1, s[8:11], s95 offen offset:3072 sc1
    buffer_load_dwordx4 v[216:219], v251, s[8:11], s95 offen offset:3072 sc1
    s_add_u32 s95, s95, 4096
    v_mfma_f32_16x16x32_bf16 v[24:27], a[100:103], v[108:111], v[24:27]
    v_pk_add_f32 v[136:137], v[136:137], v[144:145]
    v_pk_add_f32 v[138:139], v[138:139], v[146:147]
    v_mfma_f32_16x16x32_bf16 v[28:31], a[104:107], v[104:107], v[28:31]
    v_pk_add_f32 v[220:221], v[220:221], v[136:137]
    v_pk_add_f32 v[222:223], v[222:223], v[138:139]
    v_mfma_f32_16x16x32_bf16 v[32:35], a[104:107], v[108:111], v[32:35]
    v_cvt_pk_bf16_f32 v238, v220, v221
    v_cvt_pk_bf16_f32 v239, v222, v223
    v_mfma_f32_16x16x32_bf16 v[36:39], a[108:111], v[104:107], v[36:39]
    buffer_store_dwordx2 v[238:239], v249, s[20:23], s46 offen offset:64
    v_mfma_f32_16x16x32_bf16 v[40:43], a[108:111], v[108:111], v[40:43]
    v_lshlrev_b32 v224, 16, v116
    v_mfma_f32_16x16x32_bf16 v[44:47], a[112:115], v[104:107], v[44:47]
    v_and_b32 v225, 0xffff0000, v116
    v_mfma_f32_16x16x32_bf16 v[48:51], a[112:115], v[108:111], v[48:51]
    v_lshlrev_b32 v226, 16, v117
    v_mfma_f32_16x16x32_bf16 v[52:55], a[116:119], v[104:107], v[52:55]
    v_and_b32 v227, 0xffff0000, v117
    v_mfma_f32_16x16x32_bf16 v[56:59], a[116:119], v[108:111], v[56:59]
    s_waitcnt vmcnt(12)
    v_mfma_f32_16x16x32_bf16 v[20:23], a[120:123], v[172:175], v[20:23]
    s_waitcnt lgkmcnt(0)
    v_lshlrev_b32 v220, 16, v246
    v_mfma_f32_16x16x32_bf16 v[24:27], a[120:123], v[176:179], v[24:27]
    v_and_b32 v221, 0xffff0000, v246
    v_lshlrev_b32 v222, 16, v247
    v_mfma_f32_16x16x32_bf16 v[28:31], a[124:127], v[172:175], v[28:31]
    v_and_b32 v223, 0xffff0000, v247
    v_mfma_f32_16x16x32_bf16 v[32:35], a[124:127], v[176:179], v[32:35]
    v_pk_add_f32 v[152:153], v[152:153], v[156:157]
    v_mfma_f32_16x16x32_bf16 v[36:39], a[128:131], v[172:175], v[36:39]
    v_pk_add_f32 v[160:161], v[160:161], v[164:165]
    v_mfma_f32_16x16x32_bf16 v[40:43], a[128:131], v[176:179], v[40:43]
    v_pk_add_f32 v[154:155], v[154:155], v[158:159]
    v_mfma_f32_16x16x32_bf16 v[44:47], a[132:135], v[172:175], v[44:47]
    v_pk_add_f32 v[162:163], v[162:163], v[166:167]
    v_mfma_f32_16x16x32_bf16 v[48:51], a[132:135], v[176:179], v[48:51]
    v_pk_add_f32 v[220:221], v[220:221], v[224:225]
    v_mfma_f32_16x16x32_bf16 v[52:55], a[136:139], v[172:175], v[52:55]
    v_pk_add_f32 v[222:223], v[222:223], v[226:227]
    v_mfma_f32_16x16x32_bf16 v[56:59], a[136:139], v[176:179], v[56:59]
    s_waitcnt vmcnt(10)
    v_mfma_f32_16x16x32_bf16 v[20:23], a[140:143], v[180:183], v[20:23]
    v_pk_add_f32 v[152:153], v[152:153], v[160:161]
    v_mfma_f32_16x16x32_bf16 v[24:27], a[140:143], v[184:187], v[24:27]
    v_pk_add_f32 v[154:155], v[154:155], v[162:163]
    v_mfma_f32_16x16x32_bf16 v[28:31], a[144:147], v[180:183], v[28:31]
    v_pk_add_f32 v[220:221], v[220:221], v[152:153]
    v_mfma_f32_16x16x32_bf16 v[32:35], a[144:147], v[184:187], v[32:35]
    v_pk_add_f32 v[222:223], v[222:223], v[154:155]
    v_mfma_f32_16x16x32_bf16 v[36:39], a[148:151], v[180:183], v[36:39]
    v_cvt_pk_bf16_f32 v240, v220, v221
    v_mfma_f32_16x16x32_bf16 v[40:43], a[148:151], v[184:187], v[40:43]
    v_cvt_pk_bf16_f32 v241, v222, v223
    v_mfma_f32_16x16x32_bf16 v[44:47], a[152:155], v[180:183], v[44:47]
    buffer_store_dwordx2 v[240:241], v249, s[20:23], s43 offen offset:128
    v_mfma_f32_16x16x32_bf16 v[48:51], a[152:155], v[184:187], v[48:51]
    v_mfma_f32_16x16x32_bf16 v[52:55], a[156:159], v[180:183], v[52:55]
    v_mfma_f32_16x16x32_bf16 v[56:59], a[156:159], v[184:187], v[56:59]
    s_waitcnt vmcnt(9)
    v_mfma_f32_16x16x32_bf16 v[20:23], a[160:163], v[188:191], v[20:23]
    v_add_u32 v9, s51, v1
    v_mfma_f32_16x16x32_bf16 v[24:27], a[160:163], v[192:195], v[24:27]
    ds_read_b128 v[140:143], v9 offset:0
    v_mfma_f32_16x16x32_bf16 v[28:31], a[164:167], v[188:191], v[28:31]
    ds_read_b128 v[144:147], v9 offset:1024
    v_mfma_f32_16x16x32_bf16 v[32:35], a[164:167], v[192:195], v[32:35]
    ds_read_b128 v[148:151], v9 offset:2048
    v_mfma_f32_16x16x32_bf16 v[36:39], a[168:171], v[188:191], v[36:39]
    ds_read_b128 v[152:155], v9 offset:3072
    v_mfma_f32_16x16x32_bf16 v[40:43], a[168:171], v[192:195], v[40:43]
    ds_read_b128 v[156:159], v9 offset:4096
    v_mfma_f32_16x16x32_bf16 v[44:47], a[172:175], v[188:191], v[44:47]
    v_mfma_f32_16x16x32_bf16 v[48:51], a[172:175], v[192:195], v[48:51]
    v_mfma_f32_16x16x32_bf16 v[52:55], a[176:179], v[188:191], v[52:55]
    v_mfma_f32_16x16x32_bf16 v[56:59], a[176:179], v[192:195], v[56:59]
    s_waitcnt vmcnt(7)
    s_waitcnt lgkmcnt(0)
    v_mfma_f32_16x16x32_bf16 v[20:23], v[140:143], v[196:199], v[20:23]
    ds_read_b128 v[120:123], v9 offset:5120
    v_mfma_f32_16x16x32_bf16 v[24:27], v[140:143], v[200:203], v[24:27]
    ds_read_b128 v[124:127], v9 offset:6144
    v_mfma_f32_16x16x32_bf16 v[28:31], v[144:147], v[196:199], v[28:31]
    ds_read_b128 v[128:131], v9 offset:7168
    v_mfma_f32_16x16x32_bf16 v[32:35], v[144:147], v[200:203], v[32:35]
    ds_read_b128 v[132:135], v9 offset:8192
    v_mfma_f32_16x16x32_bf16 v[36:39], v[148:151], v[196:199], v[36:39]
    ds_read_b128 v[136:139], v9 offset:9216
    v_mfma_f32_16x16x32_bf16 v[40:43], v[148:151], v[200:203], v[40:43]
    v_mfma_f32_16x16x32_bf16 v[44:47], v[152:155], v[196:199], v[44:47]
    v_mfma_f32_16x16x32_bf16 v[48:51], v[152:155], v[200:203], v[48:51]
    v_mfma_f32_16x16x32_bf16 v[52:55], v[156:159], v[196:199], v[52:55]
    v_mfma_f32_16x16x32_bf16 v[56:59], v[156:159], v[200:203], v[56:59]
    s_waitcnt vmcnt(4)
    s_waitcnt lgkmcnt(0)
    v_mfma_f32_16x16x32_bf16 v[20:23], v[120:123], v[204:207], v[20:23]
    ds_read_b128 v[140:143], v9 offset:10240
    v_mfma_f32_16x16x32_bf16 v[24:27], v[120:123], v[208:211], v[24:27]
    ds_read_b128 v[144:147], v9 offset:11264
    v_mfma_f32_16x16x32_bf16 v[28:31], v[124:127], v[204:207], v[28:31]
    ds_read_b128 v[148:151], v9 offset:12288
    v_mfma_f32_16x16x32_bf16 v[32:35], v[124:127], v[208:211], v[32:35]
    ds_read_b128 v[152:155], v9 offset:13312
    v_mfma_f32_16x16x32_bf16 v[36:39], v[128:131], v[204:207], v[36:39]
    ds_read_b128 v[156:159], v9 offset:14336
    v_mfma_f32_16x16x32_bf16 v[40:43], v[128:131], v[208:211], v[40:43]
    v_mfma_f32_16x16x32_bf16 v[44:47], v[132:135], v[204:207], v[44:47]
    v_mfma_f32_16x16x32_bf16 v[48:51], v[132:135], v[208:211], v[48:51]
    v_mfma_f32_16x16x32_bf16 v[52:55], v[136:139], v[204:207], v[52:55]
    v_mfma_f32_16x16x32_bf16 v[56:59], v[136:139], v[208:211], v[56:59]
    s_waitcnt vmcnt(2)
    s_waitcnt lgkmcnt(0)
    v_mfma_f32_16x16x32_bf16 v[20:23], v[140:143], v[212:215], v[20:23]
    v_mfma_f32_16x16x32_bf16 v[24:27], v[140:143], v[216:219], v[24:27]
    v_mfma_f32_16x16x32_bf16 v[28:31], v[144:147], v[212:215], v[28:31]
    v_mfma_f32_16x16x32_bf16 v[32:35], v[144:147], v[216:219], v[32:35]
    v_mfma_f32_16x16x32_bf16 v[36:39], v[148:151], v[212:215], v[36:39]
    v_mfma_f32_16x16x32_bf16 v[40:43], v[148:151], v[216:219], v[40:43]
    v_mfma_f32_16x16x32_bf16 v[44:47], v[152:155], v[212:215], v[44:47]
    v_mfma_f32_16x16x32_bf16 v[48:51], v[152:155], v[216:219], v[48:51]
    v_mfma_f32_16x16x32_bf16 v[52:55], v[156:159], v[212:215], v[52:55]
    v_mfma_f32_16x16x32_bf16 v[56:59], v[156:159], v[216:219], v[56:59]
    s_mul_i32 s66, s3, 9216
    v_add_u32 v4, s66, v250
    s_nop 5
    s_barrier
    ds_write_b128 v4, v[20:23] offset:0
    ds_write_b128 v4, v[24:27] offset:1024
    ds_write_b128 v4, v[28:31] offset:2048
    ds_write_b128 v4, v[32:35] offset:3072
    ds_write_b128 v4, v[36:39] offset:4096
    ds_write_b128 v4, v[40:43] offset:5120
    ds_write_b128 v4, v[44:47] offset:6144
    ds_write_b128 v4, v[48:51] offset:7168
    ds_write_b128 v4, v[52:55] offset:8192
    ds_write_b128 v4, v[56:59] offset:9216
    s_waitcnt lgkmcnt(0)
    s_barrier
    s_add_u32 s46, s46, 1310720
    s_cmp_ge_u32 s3, 2
    s_cselect_b32 s43, 0x7ffff000, s46
    ds_read_b128 v[120:123], v250 offset:0
    ds_read_b128 v[124:127], v250 offset:10240
    ds_read_b128 v[128:131], v250 offset:20480
    ds_read_b128 v[132:135], v250 offset:30720
    ds_read_b64_tr_b16 v[242:243], v248 offset:0
    ds_read_b128 v[136:139], v250 offset:4096
    ds_read_b128 v[140:143], v250 offset:14336
    ds_read_b128 v[144:147], v250 offset:24576
    ds_read_b128 v[148:151], v250 offset:34816
    ds_read_b64_tr_b16 v[244:245], v248 offset:2048
    ds_read_b128 v[152:155], v250 offset:8192
    ds_read_b128 v[156:159], v250 offset:18432
    ds_read_b128 v[160:163], v250 offset:28672
    ds_read_b128 v[164:167], v250 offset:38912
    ds_read_b64_tr_b16 v[246:247], v248 offset:4096
    v_lshlrev_b32 v224, 16, v112
    v_and_b32 v225, 0xffff0000, v112
    v_lshlrev_b32 v226, 16, v113
    v_and_b32 v227, 0xffff0000, v113
    s_waitcnt lgkmcnt(10)
    v_lshlrev_b32 v220, 16, v242
    v_and_b32 v221, 0xffff0000, v242
    v_lshlrev_b32 v222, 16, v243
    v_and_b32 v223, 0xffff0000, v243
    v_pk_add_f32 v[120:121], v[120:121], v[124:125]
    v_pk_add_f32 v[128:129], v[128:129], v[132:133]
    v_pk_add_f32 v[122:123], v[122:123], v[126:127]
    v_pk_add_f32 v[130:131], v[130:131], v[134:135]
    v_pk_add_f32 v[220:221], v[220:221], v[224:225]
    v_pk_add_f32 v[222:223], v[222:223], v[226:227]
    v_pk_add_f32 v[120:121], v[120:121], v[128:129]
    v_pk_add_f32 v[122:123], v[122:123], v[130:131]
    v_pk_add_f32 v[220:221], v[220:221], v[120:121]
    v_pk_add_f32 v[222:223], v[222:223], v[122:123]
    v_cvt_pk_bf16_f32 v236, v220, v221
    v_cvt_pk_bf16_f32 v237, v222, v223
    buffer_store_dwordx2 v[236:237], v249, s[20:23], s46 offen offset:0
    v_lshlrev_b32 v224, 16, v114
    v_and_b32 v225, 0xffff0000, v114
    v_lshlrev_b32 v226, 16, v115
    v_and_b32 v227, 0xffff0000, v115
    s_waitcnt lgkmcnt(5)
    v_lshlrev_b32 v220, 16, v244
    v_and_b32 v221, 0xffff0000, v244
    v_lshlrev_b32 v222, 16, v245
    v_and_b32 v223, 0xffff0000, v245
    v_pk_add_f32 v[136:137], v[136:137], v[140:141]
    v_pk_add_f32 v[144:145], v[144:145], v[148:149]
    v_pk_add_f32 v[138:139], v[138:139], v[142:143]
    v_pk_add_f32 v[146:147], v[146:147], v[150:151]
    v_pk_add_f32 v[220:221], v[220:221], v[224:225]
    v_pk_add_f32 v[222:223], v[222:223], v[226:227]
    v_pk_add_f32 v[136:137], v[136:137], v[144:145]
    v_pk_add_f32 v[138:139], v[138:139], v[146:147]
    v_pk_add_f32 v[220:221], v[220:221], v[136:137]
    v_pk_add_f32 v[222:223], v[222:223], v[138:139]
    v_cvt_pk_bf16_f32 v238, v220, v221
    v_cvt_pk_bf16_f32 v239, v222, v223
    buffer_store_dwordx2 v[238:239], v249, s[20:23], s46 offen offset:64
    v_lshlrev_b32 v224, 16, v116
    v_and_b32 v225, 0xffff0000, v116
    v_lshlrev_b32 v226, 16, v117
    v_and_b32 v227, 0xffff0000, v117
    s_waitcnt lgkmcnt(0)
    v_lshlrev_b32 v220, 16, v246
    v_and_b32 v221, 0xffff0000, v246
    v_lshlrev_b32 v222, 16, v247
    v_and_b32 v223, 0xffff0000, v247
    v_pk_add_f32 v[152:153], v[152:153], v[156:157]
    v_pk_add_f32 v[160:161], v[160:161], v[164:165]
    v_pk_add_f32 v[154:155], v[154:155], v[158:159]
    v_pk_add_f32 v[162:163], v[162:163], v[166:167]
    v_pk_add_f32 v[220:221], v[220:221], v[224:225]
    v_pk_add_f32 v[222:223], v[222:223], v[226:227]
    v_pk_add_f32 v[152:153], v[152:153], v[160:161]
    v_pk_add_f32 v[154:155], v[154:155], v[162:163]
    v_pk_add_f32 v[220:221], v[220:221], v[152:153]
    v_pk_add_f32 v[222:223], v[222:223], v[154:155]
    v_cvt_pk_bf16_f32 v240, v220, v221
    v_cvt_pk_bf16_f32 v241, v222, v223
    buffer_store_dwordx2 v[240:241], v249, s[20:23], s43 offen offset:128
L_end:
    s_endpgm
L_bail:
    s_mov_b64 exec, 1
    v_mov_b32 v252, 0xdead
    v_mov_b32 v253, 4
    buffer_store_dword v252, v253, s[28:31], 0 offen
    s_endpgm

.section .rodata,"a"
.p2align 6
.amdhsa_kernel sequential_preLN__ssm_conv_h3__dense_activation_gelu__prompt_kernel
  .amdhsa_next_free_vgpr 512
  .amdhsa_next_free_sgpr 102
  .amdhsa_accum_offset 256
  .amdhsa_group_segment_fixed_size 0
  .amdhsa_kernarg_size 112
  .amdhsa_user_sgpr_count 2
  .amdhsa_user_sgpr_kernarg_segment_ptr 1
  .amdhsa_system_sgpr_workgroup_id_x 1
  .amdhsa_float_denorm_mode_32 3
.end_amdhsa_kernel
```
